```python
import torch

def _softmax(x, axis=-1):
    return torch.softmax(x, dim=axis)
def _gelu(x):
    return torch.nn.functional.gelu(x, approximate="tanh")
def _silu(x):
    return torch.nn.functional.silu(x)
def _sigmoid(x):
    return torch.sigmoid(x)
def _layernorm(x, axis=-1, eps=1e-5):
    m = x.mean(dim=axis, keepdim=True)
    v = x.var(dim=axis, keepdim=True, unbiased=False)
    return (x - m) / torch.sqrt(v + eps)
def _scatter_add(tgt, idx, src, axis=0):
    return tgt.clone().index_add_(axis, idx, src)
def _segment_sum(src, seg, n):
    out = torch.zeros((n,) + src.shape[1:], dtype=src.dtype)
    return out.index_add_(0, seg, src)
def _pad(x, pw):
    flat = tuple(v for pair in reversed(pw) for v in pair)
    return torch.nn.functional.pad(x, flat)

kernel_name = 'parallel_sum__gqa_block_cached__glu_gated_reglu__decode'

def setup_inputs():

    _w = (lambda a: (lambda t: t.to(torch.bfloat16) if t.is_floating_point() else t)(torch.as_tensor(a)))
    def _A_setup():
        B, Sq, D = 1, 1, 640
        Hq, Hkv, Sk, Dh = 32, 32, 16384, 192
        assert Hq % Hkv == 0, (Hq, Hkv)
        return {
            "x": _w((lambda *s: torch.randn(*s, dtype=torch.bfloat16) * 0.05)(B, Sq, D)),
            "k_cache": _w((lambda *s: torch.randn(*s, dtype=torch.bfloat16) * 3.2)(B, Hkv, Sk, Dh)),
            "v_cache": _w((lambda *s: torch.randn(*s, dtype=torch.bfloat16) * 1.6)(B, Hkv, Sk, Dh)),
            "wq": _w((lambda *s: torch.randn(*s, dtype=torch.bfloat16) * 3.2)(D, Hq * Dh) * (D ** -0.5)),
            "wo": _w((lambda *s: torch.randn(*s, dtype=torch.bfloat16) * 1.6)(Hq * Dh, D) * ((Hq * Dh) ** -0.5)),
        }
    _A_in = _A_setup()

    def _B_setup():
        B, S, D, F = 1, 1, 640, 1536
        return {
            "x": _w((lambda *s: torch.randn(*s, dtype=torch.bfloat16) * 0.05)(B, S, D)),
            "W_gate": _w((lambda *s: torch.randn(*s, dtype=torch.bfloat16) * 1.6)(D, F) * (2.0 / D) ** 0.5),
            "W_up": _w((lambda *s: torch.randn(*s, dtype=torch.bfloat16) * 1.6)(D, F) * (2.0 / D) ** 0.5),
            "W_down": _w((lambda *s: torch.randn(*s, dtype=torch.bfloat16) * 1.6)(F, D) * (1.0 / F) ** 0.5),
        }
    _B_in = _B_setup()

    return {
        "A_x": _A_in["x"],
        "A_k_cache": _A_in["k_cache"],
        "A_v_cache": _A_in["v_cache"],
        "A_wq": _A_in["wq"],
        "A_wo": _A_in["wo"],
        "B_x": _B_in["x"],
        "B_W_gate": _B_in["W_gate"],
        "B_W_up": _B_in["W_up"],
        "B_W_down": _B_in["W_down"],
    }

def reference(A_x, A_k_cache, A_v_cache, A_wq, A_wo, B_x, B_W_gate, B_W_up, B_W_down):
    def _A_ref(x, k_cache, v_cache, wq, wo):
        B, Sq, D = x.shape
        Hq, Dh = 32, 192
        Hkv = k_cache.shape[1]
        rep = Hq // Hkv
        q = (lambda x, *d: x.permute(*d))((x @ wq).reshape(B, Sq, Hq, Dh), 0, 2, 1, 3)
        k = (lambda x, n, axis: torch.repeat_interleave(x, n, dim=axis))(k_cache, rep, axis=1)
        v = (lambda x, n, axis: torch.repeat_interleave(x, n, dim=axis))(v_cache, rep, axis=1)
        scores = torch.einsum("bhqd,bhkd->bhqk", q, k) * (Dh ** -0.5)
        p = _softmax(scores, axis=-1)
        o = torch.einsum("bhqk,bhkd->bhqd", p, v)
        return (lambda x, *d: x.permute(*d))(o, 0, 2, 1, 3).reshape(B, Sq, Hq * Dh) @ wo

    def _B_ref(x, W_gate, W_up, W_down):
        gate = torch.einsum("bsd,df->bsf", x, W_gate)
        up = torch.einsum("bsd,df->bsf", x, W_up)
        gate = gate * (lambda x, dt: x.to(dt))(gate > 0, gate.dtype)
        h = gate * up
        return torch.einsum("bsf,fd->bsd", h, W_down)

    x = A_x
    xn = _layernorm(x, axis=-1)
    return x + _A_ref(xn, A_k_cache, A_v_cache, A_wq, A_wo) + _B_ref(xn, B_W_gate, B_W_up, B_W_down)
```

```asm
; @launch grid=(256,1,1) block=(384,1,1) lds=46080
.amdgcn_target "amdgcn-amd-amdhsa--gfx950"
.text
.globl parallel_sum__gqa_block_cached__glu_gated_reglu__decode_kernel
.p2align 8
.type parallel_sum__gqa_block_cached__glu_gated_reglu__decode_kernel,@function
parallel_sum__gqa_block_cached__glu_gated_reglu__decode_kernel:
    s_cmp_ge_u32 s2, 256
    s_cbranch_scc1 L_end
    s_load_dwordx16 s[16:31], s[0:1], 0
    s_load_dwordx8 s[32:39], s[0:1], 64
    v_lshrrev_b32 v2, 6, v0
    v_and_b32 v0, 63, v0
    s_nop 0
    v_readfirstlane_b32 s3, v2
    s_and_b32 s60, s2, 7
    s_lshl_b32 s60, s60, 5
    s_lshr_b32 s13, s2, 3
    s_add_u32 s60, s60, s13
    s_lshr_b32 s8, s60, 3
    s_and_b32 s9, s60, 7
    s_lshl_b32 s10, s60, 12
    s_cmp_eq_u32 s3, 0
    s_cbranch_scc1 L_helper
    s_cmp_eq_u32 s3, 5
    s_cbranch_scc1 L_ffn
    v_lshrrev_b32 v3, 3, v0
    v_and_b32 v4, 7, v0
    s_sub_u32 s3, s3, 1
    s_mul_i32 s80, s8, 6291456
    s_lshl_b32 s13, s9, 2
    s_add_u32 s13, s13, s3
    s_mul_i32 s13, s13, 12288
    s_add_u32 s80, s80, s13
    v_mul_u32_u24 v1, 384, v3
    v_lshl_add_u32 v1, v4, 4, v1
    s_mov_b32 s11, s80
    s_waitcnt lgkmcnt(0)
    s_mov_b32 s44, s18
    s_and_b32 s45, s19, 0xffff
    s_mov_b32 s46, 201326592
    s_mov_b32 s47, 0x20000
    s_add_u32 s4, s38, 3145728
    s_addc_u32 s5, s39, 0
    s_load_dword s7, s[4:5], 0
    s_barrier
    buffer_load_dwordx4 v[56:59], v1, s[44:47], s11 offen offset:0 nt
    buffer_load_dwordx4 v[60:63], v1, s[44:47], s11 offen offset:128 nt
    buffer_load_dwordx4 v[64:67], v1, s[44:47], s11 offen offset:256 nt
    s_add_u32 s11, s11, 3072
    buffer_load_dwordx4 v[68:71], v1, s[44:47], s11 offen offset:0 nt
    buffer_load_dwordx4 v[72:75], v1, s[44:47], s11 offen offset:128 nt
    buffer_load_dwordx4 v[76:79], v1, s[44:47], s11 offen offset:256 nt
    s_add_u32 s11, s11, 3072
    s_barrier
    s_waitcnt vmcnt(3)
    buffer_load_dwordx4 v[80:83], v1, s[44:47], s11 offen offset:0 nt
    buffer_load_dwordx4 v[84:87], v1, s[44:47], s11 offen offset:128 nt
    buffer_load_dwordx4 v[88:91], v1, s[44:47], s11 offen offset:256 nt
    s_add_u32 s11, s11, 3072
    s_waitcnt vmcnt(3)
    buffer_load_dwordx4 v[92:95], v1, s[44:47], s11 offen offset:0 nt
    buffer_load_dwordx4 v[96:99], v1, s[44:47], s11 offen offset:128 nt
    buffer_load_dwordx4 v[100:103], v1, s[44:47], s11 offen offset:256 nt
    s_add_u32 s11, s11, 384000
    s_waitcnt vmcnt(3)
    buffer_load_dwordx4 v[104:107], v1, s[44:47], s11 offen offset:0 nt
    buffer_load_dwordx4 v[108:111], v1, s[44:47], s11 offen offset:128 nt
    buffer_load_dwordx4 v[112:115], v1, s[44:47], s11 offen offset:256 nt
    s_add_u32 s11, s11, 3072
    s_waitcnt vmcnt(3)
    buffer_load_dwordx4 v[116:119], v1, s[44:47], s11 offen offset:0 nt
    buffer_load_dwordx4 v[120:123], v1, s[44:47], s11 offen offset:128 nt
    buffer_load_dwordx4 v[124:127], v1, s[44:47], s11 offen offset:256 nt
    s_add_u32 s11, s11, 3072
    s_waitcnt vmcnt(3)
    buffer_load_dwordx4 v[128:131], v1, s[44:47], s11 offen offset:0 nt
    buffer_load_dwordx4 v[132:135], v1, s[44:47], s11 offen offset:128 nt
    buffer_load_dwordx4 v[136:139], v1, s[44:47], s11 offen offset:256 nt
    s_add_u32 s11, s11, 3072
    s_waitcnt vmcnt(3)
    buffer_load_dwordx4 v[140:143], v1, s[44:47], s11 offen offset:0 nt
    buffer_load_dwordx4 v[144:147], v1, s[44:47], s11 offen offset:128 nt
    buffer_load_dwordx4 v[148:151], v1, s[44:47], s11 offen offset:256 nt
    s_add_u32 s11, s11, 384000
    s_mov_b32 s56, s38
    s_and_b32 s57, s39, 0xffff
    s_mov_b32 s58, 4194304
    s_mov_b32 s59, 0x20000
    s_mul_i32 s14, s3, 2176
    v_mul_u32_u24 v2, 272, v3
    v_add_u32 v2, s14, v2
    v_bfe_u32 v5, v0, 2, 1
    v_lshl_add_u32 v5, v5, 2, v2
    v_lshlrev_b32 v6, 4, v4
    s_waitcnt lgkmcnt(0)
    s_add_u32 s7, s7, 0x9e3779b9
    s_and_b32 s7, s7, 0xfffffff0
    s_mov_b32 s12, 1048576
    v_mov_b32 v53, 0
    s_branch L_qf
L_qfs:
    s_sleep 2
L_qf:
    ds_read_b32 v52, v53 offset:384
    ds_read_b128 v[32:35], v6 offset:0
    ds_read_b128 v[36:39], v6 offset:128
    ds_read_b128 v[40:43], v6 offset:256
    s_sub_u32 s12, s12, 1
    s_cbranch_scc1 L_qfx
    s_waitcnt lgkmcnt(0)
    v_readfirstlane_b32 s13, v52
    s_cmp_eq_u32 s13, 0
    s_cbranch_scc1 L_qfs
L_qfx:
    s_waitcnt lgkmcnt(0)
    s_mov_b32 s12, 8
    .p2align 6
L_k:
    s_cmp_eq_u32 s12, 1
    s_cbranch_scc0 L_k1
    s_mov_b32 s44, s20
    s_and_b32 s45, s21, 0xffff
    s_mov_b32 s11, s80
L_k1:
    v_mov_b32 v8, 0
    v_mov_b32 v9, 0
    s_waitcnt vmcnt(18)
    v_dot2c_f32_bf16 v8, v32, v56
    v_dot2c_f32_bf16 v9, v32, v68
    v_dot2c_f32_bf16 v8, v33, v57
    v_dot2c_f32_bf16 v9, v33, v69
    v_dot2c_f32_bf16 v8, v34, v58
    v_dot2c_f32_bf16 v9, v34, v70
    v_dot2c_f32_bf16 v8, v35, v59
    v_dot2c_f32_bf16 v9, v35, v71
    v_dot2c_f32_bf16 v8, v36, v60
    v_dot2c_f32_bf16 v9, v36, v72
    v_dot2c_f32_bf16 v8, v37, v61
    v_dot2c_f32_bf16 v9, v37, v73
    v_dot2c_f32_bf16 v8, v38, v62
    v_dot2c_f32_bf16 v9, v38, v74
    v_dot2c_f32_bf16 v8, v39, v63
    v_dot2c_f32_bf16 v9, v39, v75
    v_dot2c_f32_bf16 v8, v40, v64
    v_dot2c_f32_bf16 v9, v40, v76
    v_dot2c_f32_bf16 v8, v41, v65
    v_dot2c_f32_bf16 v9, v41, v77
    v_dot2c_f32_bf16 v8, v42, v66
    v_dot2c_f32_bf16 v9, v42, v78
    v_dot2c_f32_bf16 v8, v43, v67
    v_dot2c_f32_bf16 v9, v43, v79
    s_waitcnt vmcnt(3)
    buffer_load_dwordx4 v[56:59], v1, s[44:47], s11 offen offset:0 nt
    buffer_load_dwordx4 v[60:63], v1, s[44:47], s11 offen offset:128 nt
    buffer_load_dwordx4 v[64:67], v1, s[44:47], s11 offen offset:256 nt
    s_add_u32 s11, s11, 3072
    s_waitcnt vmcnt(3)
    buffer_load_dwordx4 v[68:71], v1, s[44:47], s11 offen offset:0 nt
    buffer_load_dwordx4 v[72:75], v1, s[44:47], s11 offen offset:128 nt
    buffer_load_dwordx4 v[76:79], v1, s[44:47], s11 offen offset:256 nt
    s_add_u32 s11, s11, 3072
    v_add_f32_dpp v8, v8, v8 row_half_mirror row_mask:0xf bank_mask:0x5
    v_add_f32_dpp v8, v9, v9 row_half_mirror row_mask:0xf bank_mask:0xa
    s_nop 1
    v_add_f32_dpp v8, v8, v8 quad_perm:[1,0,3,2] row_mask:0xf bank_mask:0xf
    s_nop 1
    v_add_f32_dpp v8, v8, v8 quad_perm:[2,3,0,1] row_mask:0xf bank_mask:0xf
    ds_write_b32 v5, v8 offset:5632
    v_mov_b32 v8, 0
    v_mov_b32 v9, 0
    s_waitcnt vmcnt(18)
    v_dot2c_f32_bf16 v8, v32, v80
    v_dot2c_f32_bf16 v9, v32, v92
    v_dot2c_f32_bf16 v8, v33, v81
    v_dot2c_f32_bf16 v9, v33, v93
    v_dot2c_f32_bf16 v8, v34, v82
    v_dot2c_f32_bf16 v9, v34, v94
    v_dot2c_f32_bf16 v8, v35, v83
    v_dot2c_f32_bf16 v9, v35, v95
    v_dot2c_f32_bf16 v8, v36, v84
    v_dot2c_f32_bf16 v9, v36, v96
    v_dot2c_f32_bf16 v8, v37, v85
    v_dot2c_f32_bf16 v9, v37, v97
    v_dot2c_f32_bf16 v8, v38, v86
    v_dot2c_f32_bf16 v9, v38, v98
    v_dot2c_f32_bf16 v8, v39, v87
    v_dot2c_f32_bf16 v9, v39, v99
    v_dot2c_f32_bf16 v8, v40, v88
    v_dot2c_f32_bf16 v9, v40, v100
    v_dot2c_f32_bf16 v8, v41, v89
    v_dot2c_f32_bf16 v9, v41, v101
    v_dot2c_f32_bf16 v8, v42, v90
    v_dot2c_f32_bf16 v9, v42, v102
    v_dot2c_f32_bf16 v8, v43, v91
    v_dot2c_f32_bf16 v9, v43, v103
    s_waitcnt vmcnt(3)
    buffer_load_dwordx4 v[80:83], v1, s[44:47], s11 offen offset:0 nt
    buffer_load_dwordx4 v[84:87], v1, s[44:47], s11 offen offset:128 nt
    buffer_load_dwordx4 v[88:91], v1, s[44:47], s11 offen offset:256 nt
    s_add_u32 s11, s11, 3072
    s_waitcnt vmcnt(3)
    buffer_load_dwordx4 v[92:95], v1, s[44:47], s11 offen offset:0 nt
    buffer_load_dwordx4 v[96:99], v1, s[44:47], s11 offen offset:128 nt
    buffer_load_dwordx4 v[100:103], v1, s[44:47], s11 offen offset:256 nt
    s_add_u32 s11, s11, 384000
    v_add_f32_dpp v8, v8, v8 row_half_mirror row_mask:0xf bank_mask:0x5
    v_add_f32_dpp v8, v9, v9 row_half_mirror row_mask:0xf bank_mask:0xa
    s_nop 1
    v_add_f32_dpp v8, v8, v8 quad_perm:[1,0,3,2] row_mask:0xf bank_mask:0xf
    s_nop 1
    v_add_f32_dpp v8, v8, v8 quad_perm:[2,3,0,1] row_mask:0xf bank_mask:0xf
    ds_write_b32 v5, v8 offset:5640
    v_mov_b32 v8, 0
    v_mov_b32 v9, 0
    s_waitcnt vmcnt(18)
    v_dot2c_f32_bf16 v8, v32, v104
    v_dot2c_f32_bf16 v9, v32, v116
    v_dot2c_f32_bf16 v8, v33, v105
    v_dot2c_f32_bf16 v9, v33, v117
    v_dot2c_f32_bf16 v8, v34, v106
    v_dot2c_f32_bf16 v9, v34, v118
    v_dot2c_f32_bf16 v8, v35, v107
    v_dot2c_f32_bf16 v9, v35, v119
    v_dot2c_f32_bf16 v8, v36, v108
    v_dot2c_f32_bf16 v9, v36, v120
    v_dot2c_f32_bf16 v8, v37, v109
    v_dot2c_f32_bf16 v9, v37, v121
    v_dot2c_f32_bf16 v8, v38, v110
    v_dot2c_f32_bf16 v9, v38, v122
    v_dot2c_f32_bf16 v8, v39, v111
    v_dot2c_f32_bf16 v9, v39, v123
    v_dot2c_f32_bf16 v8, v40, v112
    v_dot2c_f32_bf16 v9, v40, v124
    v_dot2c_f32_bf16 v8, v41, v113
    v_dot2c_f32_bf16 v9, v41, v125
    v_dot2c_f32_bf16 v8, v42, v114
    v_dot2c_f32_bf16 v9, v42, v126
    v_dot2c_f32_bf16 v8, v43, v115
    v_dot2c_f32_bf16 v9, v43, v127
    s_waitcnt vmcnt(3)
    buffer_load_dwordx4 v[104:107], v1, s[44:47], s11 offen offset:0 nt
    buffer_load_dwordx4 v[108:111], v1, s[44:47], s11 offen offset:128 nt
    buffer_load_dwordx4 v[112:115], v1, s[44:47], s11 offen offset:256 nt
    s_add_u32 s11, s11, 3072
    s_waitcnt vmcnt(3)
    buffer_load_dwordx4 v[116:119], v1, s[44:47], s11 offen offset:0 nt
    buffer_load_dwordx4 v[120:123], v1, s[44:47], s11 offen offset:128 nt
    buffer_load_dwordx4 v[124:127], v1, s[44:47], s11 offen offset:256 nt
    s_add_u32 s11, s11, 3072
    v_add_f32_dpp v8, v8, v8 row_half_mirror row_mask:0xf bank_mask:0x5
    v_add_f32_dpp v8, v9, v9 row_half_mirror row_mask:0xf bank_mask:0xa
    s_nop 1
    v_add_f32_dpp v8, v8, v8 quad_perm:[1,0,3,2] row_mask:0xf bank_mask:0xf
    s_nop 1
    v_add_f32_dpp v8, v8, v8 quad_perm:[2,3,0,1] row_mask:0xf bank_mask:0xf
    ds_write_b32 v5, v8 offset:5648
    v_mov_b32 v8, 0
    v_mov_b32 v9, 0
    s_waitcnt vmcnt(18)
    v_dot2c_f32_bf16 v8, v32, v128
    v_dot2c_f32_bf16 v9, v32, v140
    v_dot2c_f32_bf16 v8, v33, v129
    v_dot2c_f32_bf16 v9, v33, v141
    v_dot2c_f32_bf16 v8, v34, v130
    v_dot2c_f32_bf16 v9, v34, v142
    v_dot2c_f32_bf16 v8, v35, v131
    v_dot2c_f32_bf16 v9, v35, v143
    v_dot2c_f32_bf16 v8, v36, v132
    v_dot2c_f32_bf16 v9, v36, v144
    v_dot2c_f32_bf16 v8, v37, v133
    v_dot2c_f32_bf16 v9, v37, v145
    v_dot2c_f32_bf16 v8, v38, v134
    v_dot2c_f32_bf16 v9, v38, v146
    v_dot2c_f32_bf16 v8, v39, v135
    v_dot2c_f32_bf16 v9, v39, v147
    v_dot2c_f32_bf16 v8, v40, v136
    v_dot2c_f32_bf16 v9, v40, v148
    v_dot2c_f32_bf16 v8, v41, v137
    v_dot2c_f32_bf16 v9, v41, v149
    v_dot2c_f32_bf16 v8, v42, v138
    v_dot2c_f32_bf16 v9, v42, v150
    v_dot2c_f32_bf16 v8, v43, v139
    v_dot2c_f32_bf16 v9, v43, v151
    s_cmp_eq_u32 s12, 1
    s_cbranch_scc1 L_f_1
    s_waitcnt vmcnt(3)
L_f_1:
    buffer_load_dwordx4 v[128:131], v1, s[44:47], s11 offen offset:0 nt
    buffer_load_dwordx4 v[132:135], v1, s[44:47], s11 offen offset:128 nt
    buffer_load_dwordx4 v[136:139], v1, s[44:47], s11 offen offset:256 nt
    s_add_u32 s11, s11, 3072
    s_cmp_eq_u32 s12, 1
    s_cbranch_scc1 L_f_2
    s_waitcnt vmcnt(3)
L_f_2:
    buffer_load_dwordx4 v[140:143], v1, s[44:47], s11 offen offset:0 nt
    buffer_load_dwordx4 v[144:147], v1, s[44:47], s11 offen offset:128 nt
    buffer_load_dwordx4 v[148:151], v1, s[44:47], s11 offen offset:256 nt
    s_add_u32 s11, s11, 384000
    v_add_f32_dpp v8, v8, v8 row_half_mirror row_mask:0xf bank_mask:0x5
    v_add_f32_dpp v8, v9, v9 row_half_mirror row_mask:0xf bank_mask:0xa
    s_nop 1
    v_add_f32_dpp v8, v8, v8 quad_perm:[1,0,3,2] row_mask:0xf bank_mask:0xf
    s_nop 1
    v_add_f32_dpp v8, v8, v8 quad_perm:[2,3,0,1] row_mask:0xf bank_mask:0xf
    ds_write_b32 v5, v8 offset:5656
    v_add_u32 v5, 32, v5
    s_sub_u32 s12, s12, 1
    s_cmp_lg_u32 s12, 0
    s_cbranch_scc1 L_k
    v_lshl_add_u32 v5, v4, 5, v2
    s_waitcnt lgkmcnt(0)
    ds_read_b128 v[8:11], v5 offset:5632
    ds_read_b128 v[12:15], v5 offset:5648
    s_waitcnt lgkmcnt(0)
    v_cvt_pk_bf16_f32 v8, v8, v8
    v_lshlrev_b32 v8, 16, v8
    v_mul_f32 v8, 0x3d93cd3a, v8
    v_cvt_pk_bf16_f32 v8, v8, v8
    v_lshlrev_b32 v8, 16, v8
    v_cvt_pk_bf16_f32 v9, v9, v9
    v_lshlrev_b32 v9, 16, v9
    v_mul_f32 v9, 0x3d93cd3a, v9
    v_cvt_pk_bf16_f32 v9, v9, v9
    v_lshlrev_b32 v9, 16, v9
    v_cvt_pk_bf16_f32 v10, v10, v10
    v_lshlrev_b32 v10, 16, v10
    v_mul_f32 v10, 0x3d93cd3a, v10
    v_cvt_pk_bf16_f32 v10, v10, v10
    v_lshlrev_b32 v10, 16, v10
    v_cvt_pk_bf16_f32 v11, v11, v11
    v_lshlrev_b32 v11, 16, v11
    v_mul_f32 v11, 0x3d93cd3a, v11
    v_cvt_pk_bf16_f32 v11, v11, v11
    v_lshlrev_b32 v11, 16, v11
    v_cvt_pk_bf16_f32 v12, v12, v12
    v_lshlrev_b32 v12, 16, v12
    v_mul_f32 v12, 0x3d93cd3a, v12
    v_cvt_pk_bf16_f32 v12, v12, v12
    v_lshlrev_b32 v12, 16, v12
    v_cvt_pk_bf16_f32 v13, v13, v13
    v_lshlrev_b32 v13, 16, v13
    v_mul_f32 v13, 0x3d93cd3a, v13
    v_cvt_pk_bf16_f32 v13, v13, v13
    v_lshlrev_b32 v13, 16, v13
    v_cvt_pk_bf16_f32 v14, v14, v14
    v_lshlrev_b32 v14, 16, v14
    v_mul_f32 v14, 0x3d93cd3a, v14
    v_cvt_pk_bf16_f32 v14, v14, v14
    v_lshlrev_b32 v14, 16, v14
    v_cvt_pk_bf16_f32 v15, v15, v15
    v_lshlrev_b32 v15, 16, v15
    v_mul_f32 v15, 0x3d93cd3a, v15
    v_cvt_pk_bf16_f32 v15, v15, v15
    v_lshlrev_b32 v15, 16, v15
    v_max3_f32 v52, v8, v9, v10
    v_max3_f32 v52, v52, v11, v12
    v_max3_f32 v52, v52, v13, v14
    v_max_f32 v52, v52, v15
    s_nop 1
    v_max_f32_dpp v52, v52, v52 quad_perm:[1,0,3,2] row_mask:0xf bank_mask:0xf
    s_nop 1
    v_max_f32_dpp v52, v52, v52 quad_perm:[2,3,0,1] row_mask:0xf bank_mask:0xf
    s_nop 1
    v_max_f32_dpp v52, v52, v52 row_half_mirror row_mask:0xf bank_mask:0xf
    s_nop 1
    v_max_f32_dpp v52, v52, v52 row_mirror row_mask:0xf bank_mask:0xf
    v_mov_b32 v54, v52
    s_nop 1
    v_permlane16_swap_b32 v52, v54
    s_nop 1
    v_max_f32 v52, v52, v54
    v_mov_b32 v54, v52
    s_nop 1
    v_permlane32_swap_b32 v52, v54
    s_nop 1
    v_max_f32 v52, v52, v54
    v_sub_f32 v8, v8, v52
    v_mul_f32 v8, 0x3fb8aa3b, v8
    v_exp_f32 v8, v8
    v_sub_f32 v9, v9, v52
    v_mul_f32 v9, 0x3fb8aa3b, v9
    v_exp_f32 v9, v9
    v_sub_f32 v10, v10, v52
    v_mul_f32 v10, 0x3fb8aa3b, v10
    v_exp_f32 v10, v10
    v_sub_f32 v11, v11, v52
    v_mul_f32 v11, 0x3fb8aa3b, v11
    v_exp_f32 v11, v11
    v_sub_f32 v12, v12, v52
    v_mul_f32 v12, 0x3fb8aa3b, v12
    v_exp_f32 v12, v12
    v_sub_f32 v13, v13, v52
    v_mul_f32 v13, 0x3fb8aa3b, v13
    v_exp_f32 v13, v13
    v_sub_f32 v14, v14, v52
    v_mul_f32 v14, 0x3fb8aa3b, v14
    v_exp_f32 v14, v14
    v_sub_f32 v15, v15, v52
    v_mul_f32 v15, 0x3fb8aa3b, v15
    v_exp_f32 v15, v15
    s_nop 0
    v_add_f32 v53, v8, v9
    v_add_f32 v53, v53, v10
    v_add_f32 v53, v53, v11
    v_add_f32 v53, v53, v12
    v_add_f32 v53, v53, v13
    v_add_f32 v53, v53, v14
    v_add_f32 v53, v53, v15
    v_cvt_pk_bf16_f32 v8, v8, 0
    v_cvt_pk_bf16_f32 v9, v9, 0
    v_cvt_pk_bf16_f32 v10, v10, 0
    v_cvt_pk_bf16_f32 v11, v11, 0
    v_cvt_pk_bf16_f32 v12, v12, 0
    v_cvt_pk_bf16_f32 v13, v13, 0
    v_cvt_pk_bf16_f32 v14, v14, 0
    v_cvt_pk_bf16_f32 v15, v15, 0
    ds_write_b128 v5, v[8:11] offset:5632
    ds_write_b128 v5, v[12:15] offset:5648
    s_nop 1
    v_add_f32_dpp v53, v53, v53 quad_perm:[1,0,3,2] row_mask:0xf bank_mask:0xf
    s_nop 1
    v_add_f32_dpp v53, v53, v53 quad_perm:[2,3,0,1] row_mask:0xf bank_mask:0xf
    s_nop 1
    v_add_f32_dpp v53, v53, v53 row_half_mirror row_mask:0xf bank_mask:0xf
    s_nop 1
    v_add_f32_dpp v53, v53, v53 row_mirror row_mask:0xf bank_mask:0xf
    v_mov_b32 v54, v53
    s_nop 1
    v_permlane16_swap_b32 v53, v54
    s_nop 1
    v_add_f32 v53, v53, v54
    v_mov_b32 v54, v53
    s_nop 1
    v_permlane32_swap_b32 v53, v54
    s_nop 1
    v_add_f32 v53, v53, v54
    s_lshl_b32 s13, s3, 3
    v_mov_b32 v5, s13
    ds_write_b64 v5, v[52:53] offset:14336
    v_mov_b32 v8, 0
    v_mov_b32 v9, 0
    v_mov_b32 v10, 0
    v_mov_b32 v11, 0
    v_mov_b32 v12, 0
    v_mov_b32 v13, 0
    v_mov_b32 v14, 0
    v_mov_b32 v15, 0
    v_mov_b32 v16, 0
    v_mov_b32 v17, 0
    v_mov_b32 v18, 0
    v_mov_b32 v19, 0
    v_mov_b32 v20, 0
    v_mov_b32 v21, 0
    v_mov_b32 v22, 0
    v_mov_b32 v23, 0
    v_mov_b32 v24, 0
    v_mov_b32 v25, 0
    v_mov_b32 v26, 0
    v_mov_b32 v27, 0
    v_mov_b32 v28, 0
    v_mov_b32 v29, 0
    v_mov_b32 v30, 0
    v_mov_b32 v31, 0
    s_waitcnt lgkmcnt(0)
    s_barrier
    v_lshrrev_b32 v204, 5, v0
    v_bfe_u32 v7, v0, 4, 1
    v_lshl_add_u32 v204, v7, 1, v204
    v_bfe_u32 v7, v0, 3, 1
    v_lshl_add_u32 v204, v7, 2, v204
    s_mul_i32 s13, s3, 40
    s_add_u32 s13, s13, 15360
    v_mul_u32_u24 v5, 3, v204
    v_lshlrev_b32 v204, 4, v204
    v_add_u32 v6, 0, v5
    v_lshrrev_b32 v53, 3, v6
    v_and_b32 v6, 7, v6
    v_lshl_add_u32 v6, v53, 6, v6
    v_lshl_add_u32 v6, v4, 3, v6
    v_mul_u32_u24 v53, 160, v6
    v_add_u32 v53, s13, v53
    v_add_u32 v6, 1, v5
    v_lshrrev_b32 v54, 3, v6
    v_and_b32 v6, 7, v6
    v_lshl_add_u32 v6, v54, 6, v6
    v_lshl_add_u32 v6, v4, 3, v6
    v_mul_u32_u24 v54, 160, v6
    v_add_u32 v54, s13, v54
    v_add_u32 v6, 2, v5
    v_lshrrev_b32 v55, 3, v6
    v_and_b32 v6, 7, v6
    v_lshl_add_u32 v6, v55, 6, v6
    v_lshl_add_u32 v6, v4, 3, v6
    v_mul_u32_u24 v55, 160, v6
    v_add_u32 v55, s13, v55
    ds_read2_b64 v[160:163], v53 offset0:0 offset1:1
    ds_read2_b64 v[164:167], v53 offset0:2 offset1:3
    ds_read_b64 v[168:169], v53 offset:32
    ds_read2_b64 v[172:175], v54 offset0:0 offset1:1
    ds_read2_b64 v[176:179], v54 offset0:2 offset1:3
    ds_read_b64 v[180:181], v54 offset:32
    ds_read2_b64 v[184:187], v55 offset0:0 offset1:1
    ds_read2_b64 v[188:191], v55 offset0:2 offset1:3
    ds_read_b64 v[192:193], v55 offset:32
    v_lshrrev_b32 v7, 4, v0
    v_and_b32 v6, 3, v0
    v_lshl_add_u32 v7, v7, 2, v6
    v_lshlrev_b32 v7, 4, v7
    v_bfe_u32 v3, v0, 2, 2
    v_lshl_add_u32 v3, v3, 12, v7
    s_lshl_b32 s14, s3, 8
    s_lshl_b32 s81, s8, 15
    s_add_u32 s81, s81, s14
    s_add_u32 s83, s81, 16384
    s_add_u32 s82, s10, s14
    v_add_u32 v7, s14, v7
    v_lshlrev_b32 v4, 4, v0
    v_add_u32 v6, s14, v4
    s_lshl_b32 s14, s3, 10
    v_add_u32 v5, s14, v4
    s_lshl_b32 s15, s3, 7
    s_add_u32 s15, s15, s10
    v_mov_b32 v200, 0
    v_mov_b32 v202, 1
    s_mov_b32 s12, 7
    .p2align 6
L_v:
    ds_read_b32 v201, v200 offset:14388
    ds_read_b128 v[32:35], v2 offset:5632
    ds_read_b128 v[36:39], v2 offset:5648
    s_waitcnt lgkmcnt(0)
    v_cmp_le_u32 vcc, s12, v201
    v_lshlrev_b32 v52, 16, v32
    s_waitcnt vmcnt(21)
    v_dot2c_f32_bf16 v8, v32, v56
    v_dot2c_f32_bf16 v9, v52, v56
    v_dot2c_f32_bf16 v10, v32, v57
    v_dot2c_f32_bf16 v11, v52, v57
    v_dot2c_f32_bf16 v12, v32, v58
    v_dot2c_f32_bf16 v13, v52, v58
    v_dot2c_f32_bf16 v14, v32, v59
    v_dot2c_f32_bf16 v15, v52, v59
    v_dot2c_f32_bf16 v16, v32, v60
    v_dot2c_f32_bf16 v17, v52, v60
    v_dot2c_f32_bf16 v18, v32, v61
    v_dot2c_f32_bf16 v19, v52, v61
    v_dot2c_f32_bf16 v20, v32, v62
    v_dot2c_f32_bf16 v21, v52, v62
    v_dot2c_f32_bf16 v22, v32, v63
    v_dot2c_f32_bf16 v23, v52, v63
    v_dot2c_f32_bf16 v24, v32, v64
    v_dot2c_f32_bf16 v25, v52, v64
    v_dot2c_f32_bf16 v26, v32, v65
    v_dot2c_f32_bf16 v27, v52, v65
    v_dot2c_f32_bf16 v28, v32, v66
    v_dot2c_f32_bf16 v29, v52, v66
    v_dot2c_f32_bf16 v30, v32, v67
    v_dot2c_f32_bf16 v31, v52, v67
    s_waitcnt vmcnt(6)
    s_cbranch_vccnz L_e_3
    s_waitcnt vmcnt(3)
L_e_3:
    buffer_load_dwordx4 v[56:59], v1, s[44:47], s11 offen offset:0 nt
    buffer_load_dwordx4 v[60:63], v1, s[44:47], s11 offen offset:128 nt
    buffer_load_dwordx4 v[64:67], v1, s[44:47], s11 offen offset:256 nt
    s_add_u32 s11, s11, 3072
    v_lshlrev_b32 v52, 16, v33
    s_waitcnt vmcnt(21)
    v_dot2c_f32_bf16 v8, v33, v68
    v_dot2c_f32_bf16 v9, v52, v68
    v_dot2c_f32_bf16 v10, v33, v69
    v_dot2c_f32_bf16 v11, v52, v69
    v_dot2c_f32_bf16 v12, v33, v70
    v_dot2c_f32_bf16 v13, v52, v70
    v_dot2c_f32_bf16 v14, v33, v71
    v_dot2c_f32_bf16 v15, v52, v71
    v_dot2c_f32_bf16 v16, v33, v72
    v_dot2c_f32_bf16 v17, v52, v72
    v_dot2c_f32_bf16 v18, v33, v73
    v_dot2c_f32_bf16 v19, v52, v73
    v_dot2c_f32_bf16 v20, v33, v74
    v_dot2c_f32_bf16 v21, v52, v74
    v_dot2c_f32_bf16 v22, v33, v75
    v_dot2c_f32_bf16 v23, v52, v75
    v_dot2c_f32_bf16 v24, v33, v76
    v_dot2c_f32_bf16 v25, v52, v76
    v_dot2c_f32_bf16 v26, v33, v77
    v_dot2c_f32_bf16 v27, v52, v77
    v_dot2c_f32_bf16 v28, v33, v78
    v_dot2c_f32_bf16 v29, v52, v78
    v_dot2c_f32_bf16 v30, v33, v79
    v_dot2c_f32_bf16 v31, v52, v79
    s_waitcnt vmcnt(6)
    s_cbranch_vccnz L_e_4
    s_waitcnt vmcnt(3)
L_e_4:
    buffer_load_dwordx4 v[68:71], v1, s[44:47], s11 offen offset:0 nt
    buffer_load_dwordx4 v[72:75], v1, s[44:47], s11 offen offset:128 nt
    buffer_load_dwordx4 v[76:79], v1, s[44:47], s11 offen offset:256 nt
    s_add_u32 s11, s11, 3072
    v_lshlrev_b32 v52, 16, v34
    s_waitcnt vmcnt(21)
    v_dot2c_f32_bf16 v8, v34, v80
    v_dot2c_f32_bf16 v9, v52, v80
    v_dot2c_f32_bf16 v10, v34, v81
    v_dot2c_f32_bf16 v11, v52, v81
    v_dot2c_f32_bf16 v12, v34, v82
    v_dot2c_f32_bf16 v13, v52, v82
    v_dot2c_f32_bf16 v14, v34, v83
    v_dot2c_f32_bf16 v15, v52, v83
    v_dot2c_f32_bf16 v16, v34, v84
    v_dot2c_f32_bf16 v17, v52, v84
    v_dot2c_f32_bf16 v18, v34, v85
    v_dot2c_f32_bf16 v19, v52, v85
    v_dot2c_f32_bf16 v20, v34, v86
    v_dot2c_f32_bf16 v21, v52, v86
    v_dot2c_f32_bf16 v22, v34, v87
    v_dot2c_f32_bf16 v23, v52, v87
    v_dot2c_f32_bf16 v24, v34, v88
    v_dot2c_f32_bf16 v25, v52, v88
    v_dot2c_f32_bf16 v26, v34, v89
    v_dot2c_f32_bf16 v27, v52, v89
    v_dot2c_f32_bf16 v28, v34, v90
    v_dot2c_f32_bf16 v29, v52, v90
    v_dot2c_f32_bf16 v30, v34, v91
    v_dot2c_f32_bf16 v31, v52, v91
    s_waitcnt vmcnt(6)
    s_cbranch_vccnz L_e_5
    s_waitcnt vmcnt(3)
L_e_5:
    buffer_load_dwordx4 v[80:83], v1, s[44:47], s11 offen offset:0 nt
    buffer_load_dwordx4 v[84:87], v1, s[44:47], s11 offen offset:128 nt
    buffer_load_dwordx4 v[88:91], v1, s[44:47], s11 offen offset:256 nt
    s_add_u32 s11, s11, 3072
    v_lshlrev_b32 v52, 16, v35
    s_waitcnt vmcnt(21)
    v_dot2c_f32_bf16 v8, v35, v92
    v_dot2c_f32_bf16 v9, v52, v92
    v_dot2c_f32_bf16 v10, v35, v93
    v_dot2c_f32_bf16 v11, v52, v93
    v_dot2c_f32_bf16 v12, v35, v94
    v_dot2c_f32_bf16 v13, v52, v94
    v_dot2c_f32_bf16 v14, v35, v95
    v_dot2c_f32_bf16 v15, v52, v95
    v_dot2c_f32_bf16 v16, v35, v96
    v_dot2c_f32_bf16 v17, v52, v96
    v_dot2c_f32_bf16 v18, v35, v97
    v_dot2c_f32_bf16 v19, v52, v97
    v_dot2c_f32_bf16 v20, v35, v98
    v_dot2c_f32_bf16 v21, v52, v98
    v_dot2c_f32_bf16 v22, v35, v99
    v_dot2c_f32_bf16 v23, v52, v99
    v_dot2c_f32_bf16 v24, v35, v100
    v_dot2c_f32_bf16 v25, v52, v100
    v_dot2c_f32_bf16 v26, v35, v101
    v_dot2c_f32_bf16 v27, v52, v101
    v_dot2c_f32_bf16 v28, v35, v102
    v_dot2c_f32_bf16 v29, v52, v102
    v_dot2c_f32_bf16 v30, v35, v103
    v_dot2c_f32_bf16 v31, v52, v103
    s_waitcnt vmcnt(6)
    s_cbranch_vccnz L_e_6
    s_waitcnt vmcnt(3)
L_e_6:
    buffer_load_dwordx4 v[92:95], v1, s[44:47], s11 offen offset:0 nt
    buffer_load_dwordx4 v[96:99], v1, s[44:47], s11 offen offset:128 nt
    buffer_load_dwordx4 v[100:103], v1, s[44:47], s11 offen offset:256 nt
    s_add_u32 s11, s11, 384000
    v_lshlrev_b32 v52, 16, v36
    s_waitcnt vmcnt(21)
    v_dot2c_f32_bf16 v8, v36, v104
    v_dot2c_f32_bf16 v9, v52, v104
    v_dot2c_f32_bf16 v10, v36, v105
    v_dot2c_f32_bf16 v11, v52, v105
    v_dot2c_f32_bf16 v12, v36, v106
    v_dot2c_f32_bf16 v13, v52, v106
    v_dot2c_f32_bf16 v14, v36, v107
    v_dot2c_f32_bf16 v15, v52, v107
    v_dot2c_f32_bf16 v16, v36, v108
    v_dot2c_f32_bf16 v17, v52, v108
    v_dot2c_f32_bf16 v18, v36, v109
    v_dot2c_f32_bf16 v19, v52, v109
    v_dot2c_f32_bf16 v20, v36, v110
    v_dot2c_f32_bf16 v21, v52, v110
    v_dot2c_f32_bf16 v22, v36, v111
    v_dot2c_f32_bf16 v23, v52, v111
    v_dot2c_f32_bf16 v24, v36, v112
    v_dot2c_f32_bf16 v25, v52, v112
    v_dot2c_f32_bf16 v26, v36, v113
    v_dot2c_f32_bf16 v27, v52, v113
    v_dot2c_f32_bf16 v28, v36, v114
    v_dot2c_f32_bf16 v29, v52, v114
    v_dot2c_f32_bf16 v30, v36, v115
    v_dot2c_f32_bf16 v31, v52, v115
    s_cmp_eq_u32 s12, 1
    s_cbranch_scc1 L_e_7
    s_waitcnt vmcnt(6)
    s_cbranch_vccnz L_e_7
    s_waitcnt vmcnt(3)
L_e_7:
    buffer_load_dwordx4 v[104:107], v1, s[44:47], s11 offen offset:0 nt
    buffer_load_dwordx4 v[108:111], v1, s[44:47], s11 offen offset:128 nt
    buffer_load_dwordx4 v[112:115], v1, s[44:47], s11 offen offset:256 nt
    s_add_u32 s11, s11, 3072
    v_lshlrev_b32 v52, 16, v37
    s_waitcnt vmcnt(21)
    v_dot2c_f32_bf16 v8, v37, v116
    v_dot2c_f32_bf16 v9, v52, v116
    v_dot2c_f32_bf16 v10, v37, v117
    v_dot2c_f32_bf16 v11, v52, v117
    v_dot2c_f32_bf16 v12, v37, v118
    v_dot2c_f32_bf16 v13, v52, v118
    v_dot2c_f32_bf16 v14, v37, v119
    v_dot2c_f32_bf16 v15, v52, v119
    v_dot2c_f32_bf16 v16, v37, v120
    v_dot2c_f32_bf16 v17, v52, v120
    v_dot2c_f32_bf16 v18, v37, v121
    v_dot2c_f32_bf16 v19, v52, v121
    v_dot2c_f32_bf16 v20, v37, v122
    v_dot2c_f32_bf16 v21, v52, v122
    v_dot2c_f32_bf16 v22, v37, v123
    v_dot2c_f32_bf16 v23, v52, v123
    v_dot2c_f32_bf16 v24, v37, v124
    v_dot2c_f32_bf16 v25, v52, v124
    v_dot2c_f32_bf16 v26, v37, v125
    v_dot2c_f32_bf16 v27, v52, v125
    v_dot2c_f32_bf16 v28, v37, v126
    v_dot2c_f32_bf16 v29, v52, v126
    v_dot2c_f32_bf16 v30, v37, v127
    v_dot2c_f32_bf16 v31, v52, v127
    s_cmp_eq_u32 s12, 1
    s_cbranch_scc1 L_e_8
    s_waitcnt vmcnt(6)
    s_cbranch_vccnz L_e_8
    s_waitcnt vmcnt(3)
L_e_8:
    buffer_load_dwordx4 v[116:119], v1, s[44:47], s11 offen offset:0 nt
    buffer_load_dwordx4 v[120:123], v1, s[44:47], s11 offen offset:128 nt
    buffer_load_dwordx4 v[124:127], v1, s[44:47], s11 offen offset:256 nt
    s_add_u32 s11, s11, 3072
    v_lshlrev_b32 v52, 16, v38
    s_waitcnt vmcnt(21)
    v_dot2c_f32_bf16 v8, v38, v128
    v_dot2c_f32_bf16 v9, v52, v128
    v_dot2c_f32_bf16 v10, v38, v129
    v_dot2c_f32_bf16 v11, v52, v129
    v_dot2c_f32_bf16 v12, v38, v130
    v_dot2c_f32_bf16 v13, v52, v130
    v_dot2c_f32_bf16 v14, v38, v131
    v_dot2c_f32_bf16 v15, v52, v131
    v_dot2c_f32_bf16 v16, v38, v132
    v_dot2c_f32_bf16 v17, v52, v132
    v_dot2c_f32_bf16 v18, v38, v133
    v_dot2c_f32_bf16 v19, v52, v133
    v_dot2c_f32_bf16 v20, v38, v134
    v_dot2c_f32_bf16 v21, v52, v134
    v_dot2c_f32_bf16 v22, v38, v135
    v_dot2c_f32_bf16 v23, v52, v135
    v_dot2c_f32_bf16 v24, v38, v136
    v_dot2c_f32_bf16 v25, v52, v136
    v_dot2c_f32_bf16 v26, v38, v137
    v_dot2c_f32_bf16 v27, v52, v137
    v_dot2c_f32_bf16 v28, v38, v138
    v_dot2c_f32_bf16 v29, v52, v138
    v_dot2c_f32_bf16 v30, v38, v139
    v_dot2c_f32_bf16 v31, v52, v139
    s_cmp_eq_u32 s12, 1
    s_cbranch_scc1 L_e_9
    s_waitcnt vmcnt(6)
    s_cbranch_vccnz L_e_9
    s_waitcnt vmcnt(3)
L_e_9:
    buffer_load_dwordx4 v[128:131], v1, s[44:47], s11 offen offset:0 nt
    buffer_load_dwordx4 v[132:135], v1, s[44:47], s11 offen offset:128 nt
    buffer_load_dwordx4 v[136:139], v1, s[44:47], s11 offen offset:256 nt
    s_add_u32 s11, s11, 3072
    v_lshlrev_b32 v52, 16, v39
    s_waitcnt vmcnt(21)
    v_dot2c_f32_bf16 v8, v39, v140
    v_dot2c_f32_bf16 v9, v52, v140
    v_dot2c_f32_bf16 v10, v39, v141
    v_dot2c_f32_bf16 v11, v52, v141
    v_dot2c_f32_bf16 v12, v39, v142
    v_dot2c_f32_bf16 v13, v52, v142
    v_dot2c_f32_bf16 v14, v39, v143
    v_dot2c_f32_bf16 v15, v52, v143
    v_dot2c_f32_bf16 v16, v39, v144
    v_dot2c_f32_bf16 v17, v52, v144
    v_dot2c_f32_bf16 v18, v39, v145
    v_dot2c_f32_bf16 v19, v52, v145
    v_dot2c_f32_bf16 v20, v39, v146
    v_dot2c_f32_bf16 v21, v52, v146
    v_dot2c_f32_bf16 v22, v39, v147
    v_dot2c_f32_bf16 v23, v52, v147
    v_dot2c_f32_bf16 v24, v39, v148
    v_dot2c_f32_bf16 v25, v52, v148
    v_dot2c_f32_bf16 v26, v39, v149
    v_dot2c_f32_bf16 v27, v52, v149
    v_dot2c_f32_bf16 v28, v39, v150
    v_dot2c_f32_bf16 v29, v52, v150
    v_dot2c_f32_bf16 v30, v39, v151
    v_dot2c_f32_bf16 v31, v52, v151
    s_cmp_eq_u32 s12, 1
    s_cbranch_scc1 L_e_10
    s_waitcnt vmcnt(6)
    s_cbranch_vccnz L_e_10
    s_waitcnt vmcnt(3)
L_e_10:
    buffer_load_dwordx4 v[140:143], v1, s[44:47], s11 offen offset:0 nt
    buffer_load_dwordx4 v[144:147], v1, s[44:47], s11 offen offset:128 nt
    buffer_load_dwordx4 v[148:151], v1, s[44:47], s11 offen offset:256 nt
    s_add_u32 s11, s11, 384000
    v_add_u32 v2, 32, v2
    s_sub_u32 s12, s12, 1
    s_cmp_lg_u32 s12, 0
    s_cbranch_scc1 L_v
    ds_read_b128 v[32:35], v2 offset:5632
    ds_read_b128 v[36:39], v2 offset:5648
    s_waitcnt lgkmcnt(0)
    v_lshlrev_b32 v52, 16, v32
    s_waitcnt vmcnt(21)
    v_dot2c_f32_bf16 v8, v32, v56
    v_dot2c_f32_bf16 v9, v52, v56
    v_dot2c_f32_bf16 v10, v32, v57
    v_dot2c_f32_bf16 v11, v52, v57
    v_dot2c_f32_bf16 v12, v32, v58
    v_dot2c_f32_bf16 v13, v52, v58
    v_dot2c_f32_bf16 v14, v32, v59
    v_dot2c_f32_bf16 v15, v52, v59
    v_dot2c_f32_bf16 v16, v32, v60
    v_dot2c_f32_bf16 v17, v52, v60
    v_dot2c_f32_bf16 v18, v32, v61
    v_dot2c_f32_bf16 v19, v52, v61
    v_dot2c_f32_bf16 v20, v32, v62
    v_dot2c_f32_bf16 v21, v52, v62
    v_dot2c_f32_bf16 v22, v32, v63
    v_dot2c_f32_bf16 v23, v52, v63
    v_dot2c_f32_bf16 v24, v32, v64
    v_dot2c_f32_bf16 v25, v52, v64
    v_dot2c_f32_bf16 v26, v32, v65
    v_dot2c_f32_bf16 v27, v52, v65
    v_dot2c_f32_bf16 v28, v32, v66
    v_dot2c_f32_bf16 v29, v52, v66
    v_dot2c_f32_bf16 v30, v32, v67
    v_dot2c_f32_bf16 v31, v52, v67
    v_lshlrev_b32 v52, 16, v33
    s_waitcnt vmcnt(18)
    v_dot2c_f32_bf16 v8, v33, v68
    v_dot2c_f32_bf16 v9, v52, v68
    v_dot2c_f32_bf16 v10, v33, v69
    v_dot2c_f32_bf16 v11, v52, v69
    v_dot2c_f32_bf16 v12, v33, v70
    v_dot2c_f32_bf16 v13, v52, v70
    v_dot2c_f32_bf16 v14, v33, v71
    v_dot2c_f32_bf16 v15, v52, v71
    v_dot2c_f32_bf16 v16, v33, v72
    v_dot2c_f32_bf16 v17, v52, v72
    v_dot2c_f32_bf16 v18, v33, v73
    v_dot2c_f32_bf16 v19, v52, v73
    v_dot2c_f32_bf16 v20, v33, v74
    v_dot2c_f32_bf16 v21, v52, v74
    v_dot2c_f32_bf16 v22, v33, v75
    v_dot2c_f32_bf16 v23, v52, v75
    v_dot2c_f32_bf16 v24, v33, v76
    v_dot2c_f32_bf16 v25, v52, v76
    v_dot2c_f32_bf16 v26, v33, v77
    v_dot2c_f32_bf16 v27, v52, v77
    v_dot2c_f32_bf16 v28, v33, v78
    v_dot2c_f32_bf16 v29, v52, v78
    v_dot2c_f32_bf16 v30, v33, v79
    v_dot2c_f32_bf16 v31, v52, v79
    v_lshlrev_b32 v52, 16, v34
    s_waitcnt vmcnt(15)
    v_dot2c_f32_bf16 v8, v34, v80
    v_dot2c_f32_bf16 v9, v52, v80
    v_dot2c_f32_bf16 v10, v34, v81
    v_dot2c_f32_bf16 v11, v52, v81
    v_dot2c_f32_bf16 v12, v34, v82
    v_dot2c_f32_bf16 v13, v52, v82
    v_dot2c_f32_bf16 v14, v34, v83
    v_dot2c_f32_bf16 v15, v52, v83
    v_dot2c_f32_bf16 v16, v34, v84
    v_dot2c_f32_bf16 v17, v52, v84
    v_dot2c_f32_bf16 v18, v34, v85
    v_dot2c_f32_bf16 v19, v52, v85
    v_dot2c_f32_bf16 v20, v34, v86
    v_dot2c_f32_bf16 v21, v52, v86
    v_dot2c_f32_bf16 v22, v34, v87
    v_dot2c_f32_bf16 v23, v52, v87
    v_dot2c_f32_bf16 v24, v34, v88
    v_dot2c_f32_bf16 v25, v52, v88
    v_dot2c_f32_bf16 v26, v34, v89
    v_dot2c_f32_bf16 v27, v52, v89
    v_dot2c_f32_bf16 v28, v34, v90
    v_dot2c_f32_bf16 v29, v52, v90
    v_dot2c_f32_bf16 v30, v34, v91
    v_dot2c_f32_bf16 v31, v52, v91
    v_lshlrev_b32 v52, 16, v35
    s_waitcnt vmcnt(12)
    v_dot2c_f32_bf16 v8, v35, v92
    v_dot2c_f32_bf16 v9, v52, v92
    v_dot2c_f32_bf16 v10, v35, v93
    v_dot2c_f32_bf16 v11, v52, v93
    v_dot2c_f32_bf16 v12, v35, v94
    v_dot2c_f32_bf16 v13, v52, v94
    v_dot2c_f32_bf16 v14, v35, v95
    v_dot2c_f32_bf16 v15, v52, v95
    v_dot2c_f32_bf16 v16, v35, v96
    v_dot2c_f32_bf16 v17, v52, v96
    v_dot2c_f32_bf16 v18, v35, v97
    v_dot2c_f32_bf16 v19, v52, v97
    v_dot2c_f32_bf16 v20, v35, v98
    v_dot2c_f32_bf16 v21, v52, v98
    v_dot2c_f32_bf16 v22, v35, v99
    v_dot2c_f32_bf16 v23, v52, v99
    v_dot2c_f32_bf16 v24, v35, v100
    v_dot2c_f32_bf16 v25, v52, v100
    v_dot2c_f32_bf16 v26, v35, v101
    v_dot2c_f32_bf16 v27, v52, v101
    v_dot2c_f32_bf16 v28, v35, v102
    v_dot2c_f32_bf16 v29, v52, v102
    v_dot2c_f32_bf16 v30, v35, v103
    v_dot2c_f32_bf16 v31, v52, v103
    v_lshlrev_b32 v52, 16, v36
    s_waitcnt vmcnt(9)
    v_dot2c_f32_bf16 v8, v36, v104
    v_dot2c_f32_bf16 v9, v52, v104
    v_dot2c_f32_bf16 v10, v36, v105
    v_dot2c_f32_bf16 v11, v52, v105
    v_dot2c_f32_bf16 v12, v36, v106
    v_dot2c_f32_bf16 v13, v52, v106
    v_dot2c_f32_bf16 v14, v36, v107
    v_dot2c_f32_bf16 v15, v52, v107
    v_dot2c_f32_bf16 v16, v36, v108
    v_dot2c_f32_bf16 v17, v52, v108
    v_dot2c_f32_bf16 v18, v36, v109
    v_dot2c_f32_bf16 v19, v52, v109
    v_dot2c_f32_bf16 v20, v36, v110
    v_dot2c_f32_bf16 v21, v52, v110
    v_dot2c_f32_bf16 v22, v36, v111
    v_dot2c_f32_bf16 v23, v52, v111
    v_dot2c_f32_bf16 v24, v36, v112
    v_dot2c_f32_bf16 v25, v52, v112
    v_dot2c_f32_bf16 v26, v36, v113
    v_dot2c_f32_bf16 v27, v52, v113
    v_dot2c_f32_bf16 v28, v36, v114
    v_dot2c_f32_bf16 v29, v52, v114
    v_dot2c_f32_bf16 v30, v36, v115
    v_dot2c_f32_bf16 v31, v52, v115
    v_lshlrev_b32 v52, 16, v37
    s_waitcnt vmcnt(6)
    v_dot2c_f32_bf16 v8, v37, v116
    v_dot2c_f32_bf16 v9, v52, v116
    v_dot2c_f32_bf16 v10, v37, v117
    v_dot2c_f32_bf16 v11, v52, v117
    v_dot2c_f32_bf16 v12, v37, v118
    v_dot2c_f32_bf16 v13, v52, v118
    v_dot2c_f32_bf16 v14, v37, v119
    v_dot2c_f32_bf16 v15, v52, v119
    v_dot2c_f32_bf16 v16, v37, v120
    v_dot2c_f32_bf16 v17, v52, v120
    v_dot2c_f32_bf16 v18, v37, v121
    v_dot2c_f32_bf16 v19, v52, v121
    v_dot2c_f32_bf16 v20, v37, v122
    v_dot2c_f32_bf16 v21, v52, v122
    v_dot2c_f32_bf16 v22, v37, v123
    v_dot2c_f32_bf16 v23, v52, v123
    v_dot2c_f32_bf16 v24, v37, v124
    v_dot2c_f32_bf16 v25, v52, v124
    v_dot2c_f32_bf16 v26, v37, v125
    v_dot2c_f32_bf16 v27, v52, v125
    v_dot2c_f32_bf16 v28, v37, v126
    v_dot2c_f32_bf16 v29, v52, v126
    v_dot2c_f32_bf16 v30, v37, v127
    v_dot2c_f32_bf16 v31, v52, v127
    v_lshlrev_b32 v52, 16, v38
    s_waitcnt vmcnt(3)
    v_dot2c_f32_bf16 v8, v38, v128
    v_dot2c_f32_bf16 v9, v52, v128
    v_dot2c_f32_bf16 v10, v38, v129
    v_dot2c_f32_bf16 v11, v52, v129
    v_dot2c_f32_bf16 v12, v38, v130
    v_dot2c_f32_bf16 v13, v52, v130
    v_dot2c_f32_bf16 v14, v38, v131
    v_dot2c_f32_bf16 v15, v52, v131
    v_dot2c_f32_bf16 v16, v38, v132
    v_dot2c_f32_bf16 v17, v52, v132
    v_dot2c_f32_bf16 v18, v38, v133
    v_dot2c_f32_bf16 v19, v52, v133
    v_dot2c_f32_bf16 v20, v38, v134
    v_dot2c_f32_bf16 v21, v52, v134
    v_dot2c_f32_bf16 v22, v38, v135
    v_dot2c_f32_bf16 v23, v52, v135
    v_dot2c_f32_bf16 v24, v38, v136
    v_dot2c_f32_bf16 v25, v52, v136
    v_dot2c_f32_bf16 v26, v38, v137
    v_dot2c_f32_bf16 v27, v52, v137
    v_dot2c_f32_bf16 v28, v38, v138
    v_dot2c_f32_bf16 v29, v52, v138
    v_dot2c_f32_bf16 v30, v38, v139
    v_dot2c_f32_bf16 v31, v52, v139
    v_lshlrev_b32 v52, 16, v39
    s_waitcnt vmcnt(0)
    v_dot2c_f32_bf16 v8, v39, v140
    v_dot2c_f32_bf16 v9, v52, v140
    v_dot2c_f32_bf16 v10, v39, v141
    v_dot2c_f32_bf16 v11, v52, v141
    v_dot2c_f32_bf16 v12, v39, v142
    v_dot2c_f32_bf16 v13, v52, v142
    v_dot2c_f32_bf16 v14, v39, v143
    v_dot2c_f32_bf16 v15, v52, v143
    v_dot2c_f32_bf16 v16, v39, v144
    v_dot2c_f32_bf16 v17, v52, v144
    v_dot2c_f32_bf16 v18, v39, v145
    v_dot2c_f32_bf16 v19, v52, v145
    v_dot2c_f32_bf16 v20, v39, v146
    v_dot2c_f32_bf16 v21, v52, v146
    v_dot2c_f32_bf16 v22, v39, v147
    v_dot2c_f32_bf16 v23, v52, v147
    v_dot2c_f32_bf16 v24, v39, v148
    v_dot2c_f32_bf16 v25, v52, v148
    v_dot2c_f32_bf16 v26, v39, v149
    v_dot2c_f32_bf16 v27, v52, v149
    v_dot2c_f32_bf16 v28, v39, v150
    v_dot2c_f32_bf16 v29, v52, v150
    v_dot2c_f32_bf16 v30, v39, v151
    v_dot2c_f32_bf16 v31, v52, v151
    s_nop 1
    v_add_f32_dpp v8, v8, v8 row_ror:8 row_mask:0xf bank_mask:0x3
    v_add_f32_dpp v9, v9, v9 row_ror:8 row_mask:0xf bank_mask:0x3
    v_add_f32_dpp v10, v10, v10 row_ror:8 row_mask:0xf bank_mask:0x3
    v_add_f32_dpp v11, v11, v11 row_ror:8 row_mask:0xf bank_mask:0x3
    v_add_f32_dpp v12, v12, v12 row_ror:8 row_mask:0xf bank_mask:0x3
    v_add_f32_dpp v13, v13, v13 row_ror:8 row_mask:0xf bank_mask:0x3
    v_add_f32_dpp v14, v14, v14 row_ror:8 row_mask:0xf bank_mask:0x3
    v_add_f32_dpp v15, v15, v15 row_ror:8 row_mask:0xf bank_mask:0x3
    v_add_f32_dpp v16, v16, v16 row_ror:8 row_mask:0xf bank_mask:0x3
    v_add_f32_dpp v17, v17, v17 row_ror:8 row_mask:0xf bank_mask:0x3
    v_add_f32_dpp v18, v18, v18 row_ror:8 row_mask:0xf bank_mask:0x3
    v_add_f32_dpp v19, v19, v19 row_ror:8 row_mask:0xf bank_mask:0x3
    v_add_f32_dpp v8, v20, v20 row_ror:8 row_mask:0xf bank_mask:0xc
    v_add_f32_dpp v9, v21, v21 row_ror:8 row_mask:0xf bank_mask:0xc
    v_add_f32_dpp v10, v22, v22 row_ror:8 row_mask:0xf bank_mask:0xc
    v_add_f32_dpp v11, v23, v23 row_ror:8 row_mask:0xf bank_mask:0xc
    v_add_f32_dpp v12, v24, v24 row_ror:8 row_mask:0xf bank_mask:0xc
    v_add_f32_dpp v13, v25, v25 row_ror:8 row_mask:0xf bank_mask:0xc
    v_add_f32_dpp v14, v26, v26 row_ror:8 row_mask:0xf bank_mask:0xc
    v_add_f32_dpp v15, v27, v27 row_ror:8 row_mask:0xf bank_mask:0xc
    v_add_f32_dpp v16, v28, v28 row_ror:8 row_mask:0xf bank_mask:0xc
    v_add_f32_dpp v17, v29, v29 row_ror:8 row_mask:0xf bank_mask:0xc
    v_add_f32_dpp v18, v30, v30 row_ror:8 row_mask:0xf bank_mask:0xc
    v_add_f32_dpp v19, v31, v31 row_ror:8 row_mask:0xf bank_mask:0xc
    s_nop 1
    v_permlane16_swap_b32 v8, v14
    v_permlane16_swap_b32 v9, v15
    v_permlane16_swap_b32 v10, v16
    v_permlane16_swap_b32 v11, v17
    v_permlane16_swap_b32 v12, v18
    v_permlane16_swap_b32 v13, v19
    s_nop 1
    v_add_f32 v8, v8, v14
    v_add_f32 v9, v9, v15
    v_add_f32 v10, v10, v16
    v_add_f32 v11, v11, v17
    v_add_f32 v12, v12, v18
    v_add_f32 v13, v13, v19
    s_nop 1
    v_permlane32_swap_b32 v8, v11
    v_permlane32_swap_b32 v9, v12
    v_permlane32_swap_b32 v10, v13
    s_nop 1
    v_add_f32 v8, v8, v11
    v_add_f32 v9, v9, v12
    v_add_f32 v10, v10, v13
    ds_write_b128 v5, v[8:11] offset:1536
    v_mov_b32 v2, 0
    s_waitcnt lgkmcnt(0)
    s_barrier
    s_mov_b64 exec, 0xffff
    ds_read_b32 v36, v2 offset:14384
    ds_read_b128 v[32:35], v2 offset:14368
    ds_read_b128 v[8:11], v6 offset:1536
    ds_read_b128 v[12:15], v6 offset:2560
    ds_read_b128 v[16:19], v6 offset:3584
    ds_read_b128 v[20:23], v6 offset:4608
    s_waitcnt lgkmcnt(3)
    v_cmp_eq_u32 vcc, 1, v36
    v_mul_f32 v28, v32, v8
    v_mul_f32 v29, v32, v9
    v_mul_f32 v30, v32, v10
    v_mov_b32 v31, s7
    s_waitcnt lgkmcnt(2)
    v_fmac_f32 v28, v33, v12
    v_fmac_f32 v29, v33, v13
    v_fmac_f32 v30, v33, v14
    s_waitcnt lgkmcnt(1)
    v_fmac_f32 v28, v34, v16
    v_fmac_f32 v29, v34, v17
    v_fmac_f32 v30, v34, v18
    s_waitcnt lgkmcnt(0)
    v_fmac_f32 v28, v35, v20
    v_fmac_f32 v29, v35, v21
    v_fmac_f32 v30, v35, v22
    s_cbranch_vccnz L_ol
    buffer_store_dwordx4 v[28:31], v4, s[56:59], s82 offen offset:1024 sc1
    s_branch L_od
L_ol:
    buffer_store_dwordx4 v[28:31], v4, s[56:59], s82 offen offset:1024
L_od:
    s_mov_b64 exec, -1
    v_mov_b32 v8, 0
    v_mov_b32 v9, 0
    v_mov_b32 v10, 0
    v_mov_b32 v11, 0
    v_mov_b32 v12, 0
    v_mov_b32 v13, 0
    v_mov_b32 v14, 0
    v_mov_b32 v15, 0
    v_mov_b32 v16, 0
    v_mov_b32 v17, 0
    v_mov_b32 v18, 0
    v_mov_b32 v19, 0
    v_mov_b32 v20, 0
    v_mov_b32 v21, 0
    v_mov_b32 v22, 0
    v_mov_b32 v23, 0
    v_mov_b32 v24, 0
    v_mov_b32 v25, 0
    v_mov_b32 v26, 0
    v_mov_b32 v27, 0
    s_mov_b32 s12, 262144
L_p1:
    buffer_load_dwordx4 v[40:43], v3, s[56:59], s81 offen offset:1024 sc1
    buffer_load_dwordx4 v[44:47], v3, s[56:59], s83 offen offset:1024 sc1
    s_sub_u32 s12, s12, 1
    s_cbranch_scc1 L_p1x
    s_waitcnt vmcnt(0)
    v_cmp_ne_u32 vcc, s7, v43
    v_cmp_ne_u32 s[4:5], s7, v47
    s_nop 0
    s_or_b64 vcc, vcc, s[4:5]
    s_cbranch_scc1 L_p1
L_p1x:
    s_waitcnt vmcnt(0)
    v_add_f32 v40, v40, v44
    v_add_f32 v41, v41, v45
    v_add_f32 v42, v42, v46
    v_add_f32_dpp v40, v40, v40 row_ror:4 row_mask:0xf bank_mask:0xf
    v_add_f32_dpp v41, v41, v41 row_ror:4 row_mask:0xf bank_mask:0xf
    v_add_f32_dpp v42, v42, v42 row_ror:4 row_mask:0xf bank_mask:0xf
    v_add_f32_dpp v40, v40, v40 row_ror:8 row_mask:0xf bank_mask:0xf
    v_add_f32_dpp v41, v41, v41 row_ror:8 row_mask:0xf bank_mask:0xf
    v_add_f32_dpp v42, v42, v42 row_ror:8 row_mask:0xf bank_mask:0xf
    v_cvt_pk_bf16_f32 v40, v40, 0
    v_cvt_pk_bf16_f32 v41, v41, 0
    v_cvt_pk_bf16_f32 v42, v42, 0
    ds_write_b128 v7, v[40:43] offset:512
    s_waitcnt lgkmcnt(0)
    s_barrier
    ds_read_b128 v[32:35], v4 offset:512
    s_waitcnt lgkmcnt(0)
    v_lshlrev_b32 v36, 16, v32
    v_lshlrev_b32 v37, 16, v33
    v_lshlrev_b32 v38, 16, v34
    v_dot2c_f32_bf16 v8, v32, v160
    v_dot2c_f32_bf16 v9, v36, v160
    v_dot2c_f32_bf16 v10, v32, v161
    v_dot2c_f32_bf16 v11, v36, v161
    v_dot2c_f32_bf16 v12, v32, v162
    v_dot2c_f32_bf16 v13, v36, v162
    v_dot2c_f32_bf16 v14, v32, v163
    v_dot2c_f32_bf16 v15, v36, v163
    v_dot2c_f32_bf16 v16, v32, v164
    v_dot2c_f32_bf16 v17, v36, v164
    v_dot2c_f32_bf16 v18, v32, v165
    v_dot2c_f32_bf16 v19, v36, v165
    v_dot2c_f32_bf16 v20, v32, v166
    v_dot2c_f32_bf16 v21, v36, v166
    v_dot2c_f32_bf16 v22, v32, v167
    v_dot2c_f32_bf16 v23, v36, v167
    v_dot2c_f32_bf16 v24, v32, v168
    v_dot2c_f32_bf16 v25, v36, v168
    v_dot2c_f32_bf16 v26, v32, v169
    v_dot2c_f32_bf16 v27, v36, v169
    v_dot2c_f32_bf16 v8, v33, v172
    v_dot2c_f32_bf16 v9, v37, v172
    v_dot2c_f32_bf16 v10, v33, v173
    v_dot2c_f32_bf16 v11, v37, v173
    v_dot2c_f32_bf16 v12, v33, v174
    v_dot2c_f32_bf16 v13, v37, v174
    v_dot2c_f32_bf16 v14, v33, v175
    v_dot2c_f32_bf16 v15, v37, v175
    v_dot2c_f32_bf16 v16, v33, v176
    v_dot2c_f32_bf16 v17, v37, v176
    v_dot2c_f32_bf16 v18, v33, v177
    v_dot2c_f32_bf16 v19, v37, v177
    v_dot2c_f32_bf16 v20, v33, v178
    v_dot2c_f32_bf16 v21, v37, v178
    v_dot2c_f32_bf16 v22, v33, v179
    v_dot2c_f32_bf16 v23, v37, v179
    v_dot2c_f32_bf16 v24, v33, v180
    v_dot2c_f32_bf16 v25, v37, v180
    v_dot2c_f32_bf16 v26, v33, v181
    v_dot2c_f32_bf16 v27, v37, v181
    v_dot2c_f32_bf16 v8, v34, v184
    v_dot2c_f32_bf16 v9, v38, v184
    v_dot2c_f32_bf16 v10, v34, v185
    v_dot2c_f32_bf16 v11, v38, v185
    v_dot2c_f32_bf16 v12, v34, v186
    v_dot2c_f32_bf16 v13, v38, v186
    v_dot2c_f32_bf16 v14, v34, v187
    v_dot2c_f32_bf16 v15, v38, v187
    v_dot2c_f32_bf16 v16, v34, v188
    v_dot2c_f32_bf16 v17, v38, v188
    v_dot2c_f32_bf16 v18, v34, v189
    v_dot2c_f32_bf16 v19, v38, v189
    v_dot2c_f32_bf16 v20, v34, v190
    v_dot2c_f32_bf16 v21, v38, v190
    v_dot2c_f32_bf16 v22, v34, v191
    v_dot2c_f32_bf16 v23, v38, v191
    v_dot2c_f32_bf16 v24, v34, v192
    v_dot2c_f32_bf16 v25, v38, v192
    v_dot2c_f32_bf16 v26, v34, v193
    v_dot2c_f32_bf16 v27, v38, v193
    v_add_f32_dpp v8, v8, v8 row_ror:8 row_mask:0xf bank_mask:0x3
    v_add_f32_dpp v9, v9, v9 row_ror:8 row_mask:0xf bank_mask:0x3
    v_add_f32_dpp v10, v10, v10 row_ror:8 row_mask:0xf bank_mask:0x3
    v_add_f32_dpp v11, v11, v11 row_ror:8 row_mask:0xf bank_mask:0x3
    v_add_f32_dpp v12, v12, v12 row_ror:8 row_mask:0xf bank_mask:0x3
    v_add_f32_dpp v13, v13, v13 row_ror:8 row_mask:0xf bank_mask:0x3
    v_add_f32_dpp v14, v14, v14 row_ror:8 row_mask:0xf bank_mask:0x3
    v_add_f32_dpp v15, v15, v15 row_ror:8 row_mask:0xf bank_mask:0x3
    v_add_f32_dpp v16, v16, v16 row_ror:8 row_mask:0xf bank_mask:0x3
    v_add_f32_dpp v17, v17, v17 row_ror:8 row_mask:0xf bank_mask:0x3
    v_add_f32_dpp v8, v18, v18 row_ror:8 row_mask:0xf bank_mask:0xc
    v_add_f32_dpp v9, v19, v19 row_ror:8 row_mask:0xf bank_mask:0xc
    v_add_f32_dpp v10, v20, v20 row_ror:8 row_mask:0xf bank_mask:0xc
    v_add_f32_dpp v11, v21, v21 row_ror:8 row_mask:0xf bank_mask:0xc
    v_add_f32_dpp v12, v22, v22 row_ror:8 row_mask:0xf bank_mask:0xc
    v_add_f32_dpp v13, v23, v23 row_ror:8 row_mask:0xf bank_mask:0xc
    v_add_f32_dpp v14, v24, v24 row_ror:8 row_mask:0xf bank_mask:0xc
    v_add_f32_dpp v15, v25, v25 row_ror:8 row_mask:0xf bank_mask:0xc
    v_add_f32_dpp v16, v26, v26 row_ror:8 row_mask:0xf bank_mask:0xc
    v_add_f32_dpp v17, v27, v27 row_ror:8 row_mask:0xf bank_mask:0xc
    s_nop 1
    v_permlane16_swap_b32 v8, v13
    v_permlane16_swap_b32 v9, v14
    v_permlane16_swap_b32 v10, v15
    v_permlane16_swap_b32 v11, v16
    v_permlane16_swap_b32 v12, v17
    s_nop 1
    v_add_f32 v8, v8, v13
    v_add_f32 v9, v9, v14
    v_add_f32 v10, v10, v15
    v_add_f32 v11, v11, v16
    v_add_f32 v12, v12, v17
    s_nop 1
    v_permlane32_swap_b32 v8, v11
    v_permlane32_swap_b32 v9, v12
    v_permlane32_swap_b32 v10, v13
    s_nop 1
    v_add_f32 v8, v8, v11
    v_add_f32 v9, v9, v12
    v_add_f32 v10, v10, v13
    v_mov_b32 v11, s7
    v_add_f32_dpp v8, v8, v8 quad_perm:[1,0,3,2] row_mask:0xf bank_mask:0xf
    v_add_f32_dpp v9, v9, v9 quad_perm:[1,0,3,2] row_mask:0xf bank_mask:0xf
    v_add_f32_dpp v10, v10, v10 quad_perm:[1,0,3,2] row_mask:0xf bank_mask:0xf
    v_add_f32_dpp v8, v8, v8 quad_perm:[2,3,0,1] row_mask:0xf bank_mask:0xf
    v_add_f32_dpp v9, v9, v9 quad_perm:[2,3,0,1] row_mask:0xf bank_mask:0xf
    v_add_f32_dpp v10, v10, v10 quad_perm:[2,3,0,1] row_mask:0xf bank_mask:0xf
    v_add_f32_dpp v8, v8, v8 row_half_mirror row_mask:0xf bank_mask:0xf
    v_add_f32_dpp v9, v9, v9 row_half_mirror row_mask:0xf bank_mask:0xf
    v_add_f32_dpp v10, v10, v10 row_half_mirror row_mask:0xf bank_mask:0xf
    s_mov_b32 exec_lo, 0x01010101
    s_mov_b32 exec_hi, 0x01010101
    buffer_store_dwordx4 v[8:11], v204, s[56:59], s15 offen offset:2048 sc1
    s_branch L_fin
L_ffn:
    s_setprio 2
    v_lshrrev_b32 v3, 3, v0
    v_and_b32 v4, 7, v0
    v_mul_u32_u24 v2, 20, v0
    v_mul_u32_u24 v1, 20, v3
    v_mul_u32_u24 v6, 3840, v0
    v_mul_u32_u24 v5, 30720, v3
    v_mul_u32_u24 v7, 12, v4
    v_add_u32 v5, v5, v7
    s_and_b32 s81, s60, 7
    s_lshr_b32 s82, s60, 3
    s_mul_i32 s13, s81, 245760
    s_mul_i32 s82, s82, 96
    s_add_u32 s13, s13, s82
    s_mul_i32 s81, s81, 160
    s_lshr_b32 s14, s60, 5
    s_mul_i32 s14, s14, 245760
    s_and_b32 s15, s60, 31
    s_mul_i32 s15, s15, 40
    s_add_u32 s14, s14, s15
    s_waitcnt lgkmcnt(0)
    s_mov_b32 s40, s16
    s_and_b32 s41, s17, 0xffff
    s_mov_b32 s42, 1280
    s_mov_b32 s43, 0x20000
    s_mov_b32 s64, s28
    s_and_b32 s65, s29, 0xffff
    s_mov_b32 s66, 1966080
    s_mov_b32 s67, 0x20000
    s_mov_b32 s68, s30
    s_and_b32 s69, s31, 0xffff
    s_mov_b32 s70, 1966080
    s_mov_b32 s71, 0x20000
    s_mov_b32 s72, s32
    s_and_b32 s73, s33, 0xffff
    s_mov_b32 s74, 1966080
    s_mov_b32 s75, 0x20000
    s_mov_b32 s56, s38
    s_and_b32 s57, s39, 0xffff
    s_mov_b32 s58, 4194304
    s_mov_b32 s59, 0x20000
    s_mov_b32 s52, s24
    s_and_b32 s53, s25, 0xffff
    s_mov_b32 s54, 7864320
    s_mov_b32 s55, 0x20000
    s_add_u32 s4, s38, 3145728
    s_addc_u32 s5, s39, 0
    s_load_dword s7, s[4:5], 0
    s_barrier
    buffer_load_dwordx4 v[56:59], v2, s[40:43], 0 offen
    buffer_load_dword v60, v2, s[40:43], 0 offen offset:16
    buffer_load_dwordx4 v[24:27], v1, s[40:43], s81 offen
    buffer_load_dword v28, v1, s[40:43], s81 offen offset:16
    buffer_load_dwordx3 v[64:66], v5, s[64:67], s13 offen nt
    buffer_load_dwordx3 v[104:106], v5, s[68:71], s13 offen nt
    s_add_u32 s13, s13, 3072
    buffer_load_dwordx3 v[68:70], v5, s[64:67], s13 offen nt
    buffer_load_dwordx3 v[108:110], v5, s[68:71], s13 offen nt
    s_add_u32 s13, s13, 3072
    buffer_load_dwordx3 v[72:74], v5, s[64:67], s13 offen nt
    buffer_load_dwordx3 v[112:114], v5, s[68:71], s13 offen nt
    s_add_u32 s13, s13, 3072
    buffer_load_dwordx3 v[76:78], v5, s[64:67], s13 offen nt
    buffer_load_dwordx3 v[116:118], v5, s[68:71], s13 offen nt
    s_add_u32 s13, s13, 3072
    buffer_load_dwordx3 v[80:82], v5, s[64:67], s13 offen nt
    buffer_load_dwordx3 v[120:122], v5, s[68:71], s13 offen nt
    s_add_u32 s13, s13, 3072
    buffer_load_dwordx3 v[84:86], v5, s[64:67], s13 offen nt
    buffer_load_dwordx3 v[124:126], v5, s[68:71], s13 offen nt
    s_add_u32 s13, s13, 3072
    buffer_load_dwordx3 v[88:90], v5, s[64:67], s13 offen nt
    buffer_load_dwordx3 v[128:130], v5, s[68:71], s13 offen nt
    s_add_u32 s13, s13, 3072
    buffer_load_dwordx3 v[92:94], v5, s[64:67], s13 offen nt
    buffer_load_dwordx3 v[132:134], v5, s[68:71], s13 offen nt
    s_add_u32 s13, s13, 3072
    buffer_load_dwordx3 v[96:98], v5, s[64:67], s13 offen nt
    buffer_load_dwordx3 v[136:138], v5, s[68:71], s13 offen nt
    s_add_u32 s13, s13, 3072
    buffer_load_dwordx3 v[100:102], v5, s[64:67], s13 offen nt
    buffer_load_dwordx3 v[140:142], v5, s[68:71], s13 offen nt
    buffer_load_dwordx4 v[144:147], v6, s[72:75], s14 offen offset:0 nt
    buffer_load_dwordx4 v[148:151], v6, s[72:75], s14 offen offset:16 nt
    buffer_load_dwordx2 v[152:153], v6, s[72:75], s14 offen offset:32 nt
    buffer_load_dwordx4 v[156:159], v6, s[72:75], s14 offen offset:1280 nt
    buffer_load_dwordx4 v[160:163], v6, s[72:75], s14 offen offset:1296 nt
    buffer_load_dwordx2 v[164:165], v6, s[72:75], s14 offen offset:1312 nt
    buffer_load_dwordx4 v[168:171], v6, s[72:75], s14 offen offset:2560 nt
    buffer_load_dwordx4 v[172:175], v6, s[72:75], s14 offen offset:2576 nt
    buffer_load_dwordx2 v[176:177], v6, s[72:75], s14 offen offset:2592 nt
    v_add_u32 v7, 0, v0
    v_mul_u32_u24 v16, 6554, v7
    v_lshrrev_b32 v16, 16, v16
    v_mul_u32_u24 v16, 1120, v16
    v_lshl_add_u32 v16, v7, 4, v16
    v_add_u32 v7, 64, v0
    v_mul_u32_u24 v17, 6554, v7
    v_lshrrev_b32 v17, 16, v17
    v_mul_u32_u24 v17, 1120, v17
    v_lshl_add_u32 v17, v7, 4, v17
    v_add_u32 v7, 128, v0
    v_mul_u32_u24 v18, 6554, v7
    v_lshrrev_b32 v18, 16, v18
    v_mul_u32_u24 v18, 1120, v18
    v_lshl_add_u32 v18, v7, 4, v18
    v_add_u32 v7, 192, v0
    v_mul_u32_u24 v19, 6554, v7
    v_lshrrev_b32 v19, 16, v19
    v_mul_u32_u24 v19, 1120, v19
    v_lshl_add_u32 v19, v7, 4, v19
    v_add_u32 v7, 256, v0
    v_mul_u32_u24 v20, 6554, v7
    v_lshrrev_b32 v20, 16, v20
    v_mul_u32_u24 v20, 1120, v20
    v_lshl_add_u32 v20, v7, 4, v20
    s_mul_i32 s62, s8, 245760
    s_mul_i32 s63, s9, 160
    s_add_u32 s62, s62, s63
    s_mov_b32 m0, 15360
    s_nop 0
    buffer_load_dwordx4 v16, s[52:55], s62 offen nt lds
    s_mov_b32 m0, 16384
    s_nop 0
    buffer_load_dwordx4 v17, s[52:55], s62 offen nt lds
    s_mov_b32 m0, 17408
    s_nop 0
    buffer_load_dwordx4 v18, s[52:55], s62 offen nt lds
    s_mov_b32 m0, 18432
    s_nop 0
    buffer_load_dwordx4 v19, s[52:55], s62 offen nt lds
    s_mov_b32 m0, 19456
    s_nop 0
    buffer_load_dwordx4 v20, s[52:55], s62 offen nt lds
    s_add_u32 s62, s62, 40960
    s_mov_b32 m0, 20480
    s_nop 0
    buffer_load_dwordx4 v16, s[52:55], s62 offen nt lds
    s_mov_b32 m0, 21504
    s_nop 0
    buffer_load_dwordx4 v17, s[52:55], s62 offen nt lds
    s_mov_b32 m0, 22528
    s_nop 0
    buffer_load_dwordx4 v18, s[52:55], s62 offen nt lds
    s_mov_b32 m0, 23552
    s_nop 0
    buffer_load_dwordx4 v19, s[52:55], s62 offen nt lds
    s_mov_b32 m0, 24576
    s_nop 0
    buffer_load_dwordx4 v20, s[52:55], s62 offen nt lds
    s_add_u32 s62, s62, 40960
    s_mov_b32 m0, 25600
    s_nop 0
    buffer_load_dwordx4 v16, s[52:55], s62 offen nt lds
    s_mov_b32 m0, 26624
    s_nop 0
    buffer_load_dwordx4 v17, s[52:55], s62 offen nt lds
    s_mov_b32 m0, 27648
    s_nop 0
    buffer_load_dwordx4 v18, s[52:55], s62 offen nt lds
    s_mov_b32 m0, 28672
    s_nop 0
    buffer_load_dwordx4 v19, s[52:55], s62 offen nt lds
    s_mov_b32 m0, 29696
    s_nop 0
    buffer_load_dwordx4 v20, s[52:55], s62 offen nt lds
    s_add_u32 s62, s62, 40960
    s_mov_b32 m0, 30720
    s_nop 0
    buffer_load_dwordx4 v16, s[52:55], s62 offen nt lds
    s_mov_b32 m0, 31744
    s_nop 0
    buffer_load_dwordx4 v17, s[52:55], s62 offen nt lds
    s_mov_b32 m0, 32768
    s_nop 0
    buffer_load_dwordx4 v18, s[52:55], s62 offen nt lds
    s_mov_b32 m0, 33792
    s_nop 0
    buffer_load_dwordx4 v19, s[52:55], s62 offen nt lds
    s_mov_b32 m0, 34816
    s_nop 0
    buffer_load_dwordx4 v20, s[52:55], s62 offen nt lds
    s_add_u32 s62, s62, 40960
    s_mov_b32 m0, 35840
    s_nop 0
    buffer_load_dwordx4 v16, s[52:55], s62 offen nt lds
    s_mov_b32 m0, 36864
    s_nop 0
    buffer_load_dwordx4 v17, s[52:55], s62 offen nt lds
    s_mov_b32 m0, 37888
    s_nop 0
    buffer_load_dwordx4 v18, s[52:55], s62 offen nt lds
    s_mov_b32 m0, 38912
    s_nop 0
    buffer_load_dwordx4 v19, s[52:55], s62 offen nt lds
    s_mov_b32 m0, 39936
    s_nop 0
    buffer_load_dwordx4 v20, s[52:55], s62 offen nt lds
    s_add_u32 s62, s62, 40960
    s_mov_b32 m0, 40960
    s_nop 0
    buffer_load_dwordx4 v16, s[52:55], s62 offen nt lds
    s_mov_b32 m0, 41984
    s_nop 0
    buffer_load_dwordx4 v17, s[52:55], s62 offen nt lds
    s_mov_b32 m0, 43008
    s_nop 0
    buffer_load_dwordx4 v18, s[52:55], s62 offen nt lds
    s_mov_b32 m0, 44032
    s_nop 0
    buffer_load_dwordx4 v19, s[52:55], s62 offen nt lds
    s_mov_b32 m0, 45056
    s_nop 0
    buffer_load_dwordx4 v20, s[52:55], s62 offen nt lds
    s_add_u32 s62, s62, 40960
    s_barrier
    s_waitcnt vmcnt(59)
    v_lshlrev_b32 v40, 16, v56
    v_and_b32 v41, 0xffff0000, v56
    v_lshlrev_b32 v42, 16, v57
    v_and_b32 v43, 0xffff0000, v57
    v_lshlrev_b32 v44, 16, v58
    v_and_b32 v45, 0xffff0000, v58
    v_lshlrev_b32 v46, 16, v59
    v_and_b32 v47, 0xffff0000, v59
    v_lshlrev_b32 v48, 16, v60
    v_and_b32 v49, 0xffff0000, v60
    v_add_f32 v52, v40, v41
    v_add_f32 v52, v52, v42
    v_add_f32 v52, v52, v43
    v_add_f32 v52, v52, v44
    v_add_f32 v52, v52, v45
    v_add_f32 v52, v52, v46
    v_add_f32 v52, v52, v47
    v_add_f32 v52, v52, v48
    v_add_f32 v52, v52, v49
    s_nop 1
    v_add_f32_dpp v52, v52, v52 quad_perm:[1,0,3,2] row_mask:0xf bank_mask:0xf
    s_nop 1
    v_add_f32_dpp v52, v52, v52 quad_perm:[2,3,0,1] row_mask:0xf bank_mask:0xf
    s_nop 1
    v_add_f32_dpp v52, v52, v52 row_half_mirror row_mask:0xf bank_mask:0xf
    s_nop 1
    v_add_f32_dpp v52, v52, v52 row_mirror row_mask:0xf bank_mask:0xf
    v_mov_b32 v54, v52
    s_nop 1
    v_permlane16_swap_b32 v52, v54
    s_nop 1
    v_add_f32 v52, v52, v54
    v_mov_b32 v54, v52
    s_nop 1
    v_permlane32_swap_b32 v52, v54
    s_nop 1
    v_add_f32 v52, v52, v54
    v_mul_f32 v52, 0x3acccccd, v52
    v_sub_f32 v54, v40, v52
    v_mul_f32 v53, v54, v54
    v_sub_f32 v54, v41, v52
    v_fmac_f32 v53, v54, v54
    v_sub_f32 v54, v42, v52
    v_fmac_f32 v53, v54, v54
    v_sub_f32 v54, v43, v52
    v_fmac_f32 v53, v54, v54
    v_sub_f32 v54, v44, v52
    v_fmac_f32 v53, v54, v54
    v_sub_f32 v54, v45, v52
    v_fmac_f32 v53, v54, v54
    v_sub_f32 v54, v46, v52
    v_fmac_f32 v53, v54, v54
    v_sub_f32 v54, v47, v52
    v_fmac_f32 v53, v54, v54
    v_sub_f32 v54, v48, v52
    v_fmac_f32 v53, v54, v54
    v_sub_f32 v54, v49, v52
    v_fmac_f32 v53, v54, v54
    s_nop 1
    v_add_f32_dpp v53, v53, v53 quad_perm:[1,0,3,2] row_mask:0xf bank_mask:0xf
    s_nop 1
    v_add_f32_dpp v53, v53, v53 quad_perm:[2,3,0,1] row_mask:0xf bank_mask:0xf
    s_nop 1
    v_add_f32_dpp v53, v53, v53 row_half_mirror row_mask:0xf bank_mask:0xf
    s_nop 1
    v_add_f32_dpp v53, v53, v53 row_mirror row_mask:0xf bank_mask:0xf
    v_mov_b32 v54, v53
    s_nop 1
    v_permlane16_swap_b32 v53, v54
    s_nop 1
    v_add_f32 v53, v53, v54
    v_mov_b32 v54, v53
    s_nop 1
    v_permlane32_swap_b32 v53, v54
    s_nop 1
    v_add_f32 v53, v53, v54
    v_mul_f32 v53, 0x3acccccd, v53
    v_cvt_pk_bf16_f32 v52, v52, v52
    v_lshlrev_b32 v52, 16, v52
    v_cvt_pk_bf16_f32 v53, v53, v53
    v_lshlrev_b32 v53, 16, v53
    v_add_f32 v53, 0x3727c5ac, v53
    v_cvt_pk_bf16_f32 v53, v53, v53
    v_lshlrev_b32 v53, 16, v53
    v_sqrt_f32 v53, v53
    s_nop 0
    v_cvt_pk_bf16_f32 v53, v53, v53
    v_lshlrev_b32 v53, 16, v53
    v_rcp_f32 v54, v53
    v_lshlrev_b32 v40, 16, v24
    v_and_b32 v41, 0xffff0000, v24
    v_lshlrev_b32 v42, 16, v25
    v_and_b32 v43, 0xffff0000, v25
    v_lshlrev_b32 v44, 16, v26
    v_and_b32 v45, 0xffff0000, v26
    v_lshlrev_b32 v46, 16, v27
    v_and_b32 v47, 0xffff0000, v27
    v_lshlrev_b32 v48, 16, v28
    v_and_b32 v49, 0xffff0000, v28
    v_sub_f32 v40, v40, v52
    v_cvt_pk_bf16_f32 v40, v40, v40
    v_lshlrev_b32 v40, 16, v40
    v_mul_f32 v55, v40, v54
    v_fma_f32 v40, -v55, v53, v40
    v_fmac_f32 v55, v40, v54
    v_cvt_pk_bf16_f32 v40, v55, 0
    v_sub_f32 v41, v41, v52
    v_cvt_pk_bf16_f32 v41, v41, v41
    v_lshlrev_b32 v41, 16, v41
    v_mul_f32 v55, v41, v54
    v_fma_f32 v41, -v55, v53, v41
    v_fmac_f32 v55, v41, v54
    v_cvt_pk_bf16_f32 v41, v55, 0
    v_sub_f32 v42, v42, v52
    v_cvt_pk_bf16_f32 v42, v42, v42
    v_lshlrev_b32 v42, 16, v42
    v_mul_f32 v55, v42, v54
    v_fma_f32 v42, -v55, v53, v42
    v_fmac_f32 v55, v42, v54
    v_cvt_pk_bf16_f32 v42, v55, 0
    v_sub_f32 v43, v43, v52
    v_cvt_pk_bf16_f32 v43, v43, v43
    v_lshlrev_b32 v43, 16, v43
    v_mul_f32 v55, v43, v54
    v_fma_f32 v43, -v55, v53, v43
    v_fmac_f32 v55, v43, v54
    v_cvt_pk_bf16_f32 v43, v55, 0
    v_sub_f32 v44, v44, v52
    v_cvt_pk_bf16_f32 v44, v44, v44
    v_lshlrev_b32 v44, 16, v44
    v_mul_f32 v55, v44, v54
    v_fma_f32 v44, -v55, v53, v44
    v_fmac_f32 v55, v44, v54
    v_cvt_pk_bf16_f32 v44, v55, 0
    v_sub_f32 v45, v45, v52
    v_cvt_pk_bf16_f32 v45, v45, v45
    v_lshlrev_b32 v45, 16, v45
    v_mul_f32 v55, v45, v54
    v_fma_f32 v45, -v55, v53, v45
    v_fmac_f32 v55, v45, v54
    v_cvt_pk_bf16_f32 v45, v55, 0
    v_sub_f32 v46, v46, v52
    v_cvt_pk_bf16_f32 v46, v46, v46
    v_lshlrev_b32 v46, 16, v46
    v_mul_f32 v55, v46, v54
    v_fma_f32 v46, -v55, v53, v46
    v_fmac_f32 v55, v46, v54
    v_cvt_pk_bf16_f32 v46, v55, 0
    v_sub_f32 v47, v47, v52
    v_cvt_pk_bf16_f32 v47, v47, v47
    v_lshlrev_b32 v47, 16, v47
    v_mul_f32 v55, v47, v54
    v_fma_f32 v47, -v55, v53, v47
    v_fmac_f32 v55, v47, v54
    v_cvt_pk_bf16_f32 v47, v55, 0
    v_sub_f32 v48, v48, v52
    v_cvt_pk_bf16_f32 v48, v48, v48
    v_lshlrev_b32 v48, 16, v48
    v_mul_f32 v55, v48, v54
    v_fma_f32 v48, -v55, v53, v48
    v_fmac_f32 v55, v48, v54
    v_cvt_pk_bf16_f32 v48, v55, 0
    v_sub_f32 v49, v49, v52
    v_cvt_pk_bf16_f32 v49, v49, v49
    v_lshlrev_b32 v49, 16, v49
    v_mul_f32 v55, v49, v54
    v_fma_f32 v49, -v55, v53, v49
    v_fmac_f32 v55, v49, v54
    v_cvt_pk_bf16_f32 v49, v55, 0
    v_mov_b32 v8, 0
    v_mov_b32 v9, 0
    v_mov_b32 v10, 0
    v_mov_b32 v11, 0
    v_mov_b32 v12, 0
    v_mov_b32 v13, 0
    v_mov_b32 v14, 0
    v_mov_b32 v15, 0
    v_mov_b32 v16, 0
    v_mov_b32 v17, 0
    v_mov_b32 v18, 0
    v_mov_b32 v19, 0
    s_waitcnt vmcnt(39)
    v_lshlrev_b32 v52, 16, v40
    v_dot2c_f32_bf16 v8, v40, v64
    v_dot2c_f32_bf16 v9, v52, v64
    v_dot2c_f32_bf16 v14, v40, v104
    v_dot2c_f32_bf16 v15, v52, v104
    v_dot2c_f32_bf16 v10, v40, v65
    v_dot2c_f32_bf16 v11, v52, v65
    v_dot2c_f32_bf16 v16, v40, v105
    v_dot2c_f32_bf16 v17, v52, v105
    v_dot2c_f32_bf16 v12, v40, v66
    v_dot2c_f32_bf16 v13, v52, v66
    v_dot2c_f32_bf16 v18, v40, v106
    v_dot2c_f32_bf16 v19, v52, v106
    v_lshlrev_b32 v52, 16, v41
    v_dot2c_f32_bf16 v8, v41, v68
    v_dot2c_f32_bf16 v9, v52, v68
    v_dot2c_f32_bf16 v14, v41, v108
    v_dot2c_f32_bf16 v15, v52, v108
    v_dot2c_f32_bf16 v10, v41, v69
    v_dot2c_f32_bf16 v11, v52, v69
    v_dot2c_f32_bf16 v16, v41, v109
    v_dot2c_f32_bf16 v17, v52, v109
    v_dot2c_f32_bf16 v12, v41, v70
    v_dot2c_f32_bf16 v13, v52, v70
    v_dot2c_f32_bf16 v18, v41, v110
    v_dot2c_f32_bf16 v19, v52, v110
    v_lshlrev_b32 v52, 16, v42
    v_dot2c_f32_bf16 v8, v42, v72
    v_dot2c_f32_bf16 v9, v52, v72
    v_dot2c_f32_bf16 v14, v42, v112
    v_dot2c_f32_bf16 v15, v52, v112
    v_dot2c_f32_bf16 v10, v42, v73
    v_dot2c_f32_bf16 v11, v52, v73
    v_dot2c_f32_bf16 v16, v42, v113
    v_dot2c_f32_bf16 v17, v52, v113
    v_dot2c_f32_bf16 v12, v42, v74
    v_dot2c_f32_bf16 v13, v52, v74
    v_dot2c_f32_bf16 v18, v42, v114
    v_dot2c_f32_bf16 v19, v52, v114
    v_lshlrev_b32 v52, 16, v43
    v_dot2c_f32_bf16 v8, v43, v76
    v_dot2c_f32_bf16 v9, v52, v76
    v_dot2c_f32_bf16 v14, v43, v116
    v_dot2c_f32_bf16 v15, v52, v116
    v_dot2c_f32_bf16 v10, v43, v77
    v_dot2c_f32_bf16 v11, v52, v77
    v_dot2c_f32_bf16 v16, v43, v117
    v_dot2c_f32_bf16 v17, v52, v117
    v_dot2c_f32_bf16 v12, v43, v78
    v_dot2c_f32_bf16 v13, v52, v78
    v_dot2c_f32_bf16 v18, v43, v118
    v_dot2c_f32_bf16 v19, v52, v118
    v_lshlrev_b32 v52, 16, v44
    v_dot2c_f32_bf16 v8, v44, v80
    v_dot2c_f32_bf16 v9, v52, v80
    v_dot2c_f32_bf16 v14, v44, v120
    v_dot2c_f32_bf16 v15, v52, v120
    v_dot2c_f32_bf16 v10, v44, v81
    v_dot2c_f32_bf16 v11, v52, v81
    v_dot2c_f32_bf16 v16, v44, v121
    v_dot2c_f32_bf16 v17, v52, v121
    v_dot2c_f32_bf16 v12, v44, v82
    v_dot2c_f32_bf16 v13, v52, v82
    v_dot2c_f32_bf16 v18, v44, v122
    v_dot2c_f32_bf16 v19, v52, v122
    v_lshlrev_b32 v52, 16, v45
    v_dot2c_f32_bf16 v8, v45, v84
    v_dot2c_f32_bf16 v9, v52, v84
    v_dot2c_f32_bf16 v14, v45, v124
    v_dot2c_f32_bf16 v15, v52, v124
    v_dot2c_f32_bf16 v10, v45, v85
    v_dot2c_f32_bf16 v11, v52, v85
    v_dot2c_f32_bf16 v16, v45, v125
    v_dot2c_f32_bf16 v17, v52, v125
    v_dot2c_f32_bf16 v12, v45, v86
    v_dot2c_f32_bf16 v13, v52, v86
    v_dot2c_f32_bf16 v18, v45, v126
    v_dot2c_f32_bf16 v19, v52, v126
    v_lshlrev_b32 v52, 16, v46
    v_dot2c_f32_bf16 v8, v46, v88
    v_dot2c_f32_bf16 v9, v52, v88
    v_dot2c_f32_bf16 v14, v46, v128
    v_dot2c_f32_bf16 v15, v52, v128
    v_dot2c_f32_bf16 v10, v46, v89
    v_dot2c_f32_bf16 v11, v52, v89
    v_dot2c_f32_bf16 v16, v46, v129
    v_dot2c_f32_bf16 v17, v52, v129
    v_dot2c_f32_bf16 v12, v46, v90
    v_dot2c_f32_bf16 v13, v52, v90
    v_dot2c_f32_bf16 v18, v46, v130
    v_dot2c_f32_bf16 v19, v52, v130
    v_lshlrev_b32 v52, 16, v47
    v_dot2c_f32_bf16 v8, v47, v92
    v_dot2c_f32_bf16 v9, v52, v92
    v_dot2c_f32_bf16 v14, v47, v132
    v_dot2c_f32_bf16 v15, v52, v132
    v_dot2c_f32_bf16 v10, v47, v93
    v_dot2c_f32_bf16 v11, v52, v93
    v_dot2c_f32_bf16 v16, v47, v133
    v_dot2c_f32_bf16 v17, v52, v133
    v_dot2c_f32_bf16 v12, v47, v94
    v_dot2c_f32_bf16 v13, v52, v94
    v_dot2c_f32_bf16 v18, v47, v134
    v_dot2c_f32_bf16 v19, v52, v134
    v_lshlrev_b32 v52, 16, v48
    v_dot2c_f32_bf16 v8, v48, v96
    v_dot2c_f32_bf16 v9, v52, v96
    v_dot2c_f32_bf16 v14, v48, v136
    v_dot2c_f32_bf16 v15, v52, v136
    v_dot2c_f32_bf16 v10, v48, v97
    v_dot2c_f32_bf16 v11, v52, v97
    v_dot2c_f32_bf16 v16, v48, v137
    v_dot2c_f32_bf16 v17, v52, v137
    v_dot2c_f32_bf16 v12, v48, v98
    v_dot2c_f32_bf16 v13, v52, v98
    v_dot2c_f32_bf16 v18, v48, v138
    v_dot2c_f32_bf16 v19, v52, v138
    v_lshlrev_b32 v52, 16, v49
    v_dot2c_f32_bf16 v8, v49, v100
    v_dot2c_f32_bf16 v9, v52, v100
    v_dot2c_f32_bf16 v14, v49, v140
    v_dot2c_f32_bf16 v15, v52, v140
    v_dot2c_f32_bf16 v10, v49, v101
    v_dot2c_f32_bf16 v11, v52, v101
    v_dot2c_f32_bf16 v16, v49, v141
    v_dot2c_f32_bf16 v17, v52, v141
    v_dot2c_f32_bf16 v12, v49, v102
    v_dot2c_f32_bf16 v13, v52, v102
    v_dot2c_f32_bf16 v18, v49, v142
    v_dot2c_f32_bf16 v19, v52, v142
    s_nop 2
    v_add_f32_dpp v8, v8, v8 row_ror:8 row_mask:0xf bank_mask:0x3
    v_add_f32_dpp v9, v9, v9 row_ror:8 row_mask:0xf bank_mask:0x3
    v_add_f32_dpp v10, v10, v10 row_ror:8 row_mask:0xf bank_mask:0x3
    v_add_f32_dpp v11, v11, v11 row_ror:8 row_mask:0xf bank_mask:0x3
    v_add_f32_dpp v12, v12, v12 row_ror:8 row_mask:0xf bank_mask:0x3
    v_add_f32_dpp v13, v13, v13 row_ror:8 row_mask:0xf bank_mask:0x3
    v_add_f32_dpp v8, v14, v14 row_ror:8 row_mask:0xf bank_mask:0xc
    v_add_f32_dpp v9, v15, v15 row_ror:8 row_mask:0xf bank_mask:0xc
    v_add_f32_dpp v10, v16, v16 row_ror:8 row_mask:0xf bank_mask:0xc
    v_add_f32_dpp v11, v17, v17 row_ror:8 row_mask:0xf bank_mask:0xc
    v_add_f32_dpp v12, v18, v18 row_ror:8 row_mask:0xf bank_mask:0xc
    v_add_f32_dpp v13, v19, v19 row_ror:8 row_mask:0xf bank_mask:0xc
    s_nop 1
    v_permlane16_swap_b32 v8, v11
    v_permlane16_swap_b32 v9, v12
    v_permlane16_swap_b32 v10, v13
    s_nop 1
    v_add_f32 v8, v8, v11
    v_add_f32 v9, v9, v12
    v_add_f32 v10, v10, v13
    v_mov_b32 v11, v8
    v_mov_b32 v12, v9
    v_mov_b32 v13, v10
    s_nop 1
    v_permlane32_swap_b32 v8, v11
    v_permlane32_swap_b32 v9, v12
    v_permlane32_swap_b32 v10, v13
    s_nop 1
    v_add_f32 v8, v8, v11
    v_add_f32 v9, v9, v12
    v_add_f32 v10, v10, v13
    v_bfe_u32 v2, v0, 3, 1
    v_lshl_add_u32 v2, v2, 3, v4
    v_bfe_u32 v7, v0, 4, 1
    v_lshl_add_u32 v2, v2, 1, v7
    v_lshlrev_b32 v3, 4, v2
    s_waitcnt lgkmcnt(0)
    s_add_u32 s7, s7, 0x9e3779b9
    s_and_b32 s7, s7, 0xfffffff0
    s_getreg_b32 s61, hwreg(HW_REG_XCC_ID)
    s_and_b32 s61, s61, 15
    s_or_b32 s61, s61, s7
    s_or_b32 s62, s7, 15
    v_mov_b32 v11, s61
    s_lshl_b32 s82, s60, 12
    s_setprio 2
    s_mov_b32 exec_hi, 0
    buffer_store_dwordx4 v[8:11], v3, s[56:59], s82 offen offset:512
    s_mov_b64 exec, -1
    v_lshrrev_b32 v2, 4, v0
    v_lshlrev_b32 v2, 15, v2
    v_and_b32 v7, 15, v0
    v_lshl_add_u32 v2, v7, 4, v2
    s_lshr_b32 s81, s60, 5
    s_lshl_b32 s81, s81, 17
    v_lshrrev_b32 v5, 5, v0
    v_bfe_u32 v7, v0, 4, 1
    v_lshl_add_u32 v5, v7, 1, v5
    v_bfe_u32 v7, v0, 3, 1
    v_lshl_add_u32 v5, v7, 2, v5
    v_lshlrev_b32 v5, 4, v5
    s_mov_b32 s12, 262144
L_phs:
    s_sleep 32
    s_cmp_lg_u32 s12, 262136
    s_cbranch_scc1 L_ph
    s_mov_b32 exec_hi, 0
    buffer_store_dwordx4 v[8:11], v3, s[56:59], s82 offen offset:512 sc1
    s_mov_b64 exec, -1
L_ph:
    s_add_u32 s83, s81, 0
    buffer_load_dwordx4 v[64:67], v2, s[56:59], s83 offen offset:512 sc1
    buffer_load_dwordx4 v[104:107], v2, s[56:59], s83 offen offset:768 sc1
    s_add_u32 s83, s81, 4096
    buffer_load_dwordx4 v[68:71], v2, s[56:59], s83 offen offset:512 sc1
    buffer_load_dwordx4 v[108:111], v2, s[56:59], s83 offen offset:768 sc1
    s_add_u32 s83, s81, 8192
    buffer_load_dwordx4 v[72:75], v2, s[56:59], s83 offen offset:512 sc1
    buffer_load_dwordx4 v[112:115], v2, s[56:59], s83 offen offset:768 sc1
    s_add_u32 s83, s81, 12288
    buffer_load_dwordx4 v[76:79], v2, s[56:59], s83 offen offset:512 sc1
    buffer_load_dwordx4 v[116:119], v2, s[56:59], s83 offen offset:768 sc1
    s_add_u32 s83, s81, 16384
    buffer_load_dwordx4 v[80:83], v2, s[56:59], s83 offen offset:512 sc1
    buffer_load_dwordx4 v[120:123], v2, s[56:59], s83 offen offset:768 sc1
    s_add_u32 s83, s81, 20480
    buffer_load_dwordx4 v[84:87], v2, s[56:59], s83 offen offset:512 sc1
    buffer_load_dwordx4 v[124:127], v2, s[56:59], s83 offen offset:768 sc1
    s_add_u32 s83, s81, 24576
    buffer_load_dwordx4 v[88:91], v2, s[56:59], s83 offen offset:512 sc1
    buffer_load_dwordx4 v[128:131], v2, s[56:59], s83 offen offset:768 sc1
    s_add_u32 s83, s81, 28672
    buffer_load_dwordx4 v[92:95], v2, s[56:59], s83 offen offset:512 sc1
    buffer_load_dwordx4 v[132:135], v2, s[56:59], s83 offen offset:768 sc1
    s_sub_u32 s12, s12, 1
    s_cbranch_scc1 L_phx
    s_waitcnt vmcnt(0)
    v_min3_u32 v52, v67, v71, v75
    v_min3_u32 v52, v52, v79, v83
    v_min3_u32 v52, v52, v87, v91
    v_min3_u32 v52, v52, v95, v107
    v_min3_u32 v52, v52, v111, v115
    v_min3_u32 v52, v52, v119, v123
    v_min3_u32 v52, v52, v127, v131
    v_min_u32 v52, v52, v135
    v_max3_u32 v53, v67, v71, v75
    v_max3_u32 v53, v53, v79, v83
    v_max3_u32 v53, v53, v87, v91
    v_max3_u32 v53, v53, v95, v107
    v_max3_u32 v53, v53, v111, v115
    v_max3_u32 v53, v53, v119, v123
    v_max3_u32 v53, v53, v127, v131
    v_max_u32 v53, v53, v135
    v_cmp_gt_u32 vcc, s7, v52
    v_cmp_lt_u32 s[4:5], s62, v53
    s_nop 0
    s_or_b64 vcc, vcc, s[4:5]
    s_cbranch_scc1 L_phs
L_phx:
    s_waitcnt vmcnt(0)
    v_cmp_ne_u32 vcc, s61, v52
    v_cmp_ne_u32 s[4:5], s61, v53
    s_nop 0
    s_or_b64 vcc, vcc, s[4:5]
    s_cbranch_scc0 L_gs
    s_mov_b32 exec_hi, 0
    buffer_store_dwordx4 v[8:11], v3, s[56:59], s82 offen offset:512 sc1
    s_mov_b64 exec, -1
    s_waitcnt vmcnt(0)
L_gs:
    v_add_f32 v64, v64, v80
    v_add_f32 v65, v65, v81
    v_add_f32 v66, v66, v82
    v_add_f32 v68, v68, v84
    v_add_f32 v69, v69, v85
    v_add_f32 v70, v70, v86
    v_add_f32 v72, v72, v88
    v_add_f32 v73, v73, v89
    v_add_f32 v74, v74, v90
    v_add_f32 v76, v76, v92
    v_add_f32 v77, v77, v93
    v_add_f32 v78, v78, v94
    v_add_f32 v64, v64, v72
    v_add_f32 v65, v65, v73
    v_add_f32 v66, v66, v74
    v_add_f32 v68, v68, v76
    v_add_f32 v69, v69, v77
    v_add_f32 v70, v70, v78
    v_add_f32 v64, v64, v68
    v_add_f32 v65, v65, v69
    v_add_f32 v66, v66, v70
    v_cvt_pk_bf16_f32 v64, v64, v64
    v_lshlrev_b32 v64, 16, v64
    v_cvt_pk_bf16_f32 v65, v65, v65
    v_lshlrev_b32 v65, 16, v65
    v_cvt_pk_bf16_f32 v66, v66, v66
    v_lshlrev_b32 v66, 16, v66
    v_add_f32 v104, v104, v120
    v_add_f32 v105, v105, v121
    v_add_f32 v106, v106, v122
    v_add_f32 v108, v108, v124
    v_add_f32 v109, v109, v125
    v_add_f32 v110, v110, v126
    v_add_f32 v112, v112, v128
    v_add_f32 v113, v113, v129
    v_add_f32 v114, v114, v130
    v_add_f32 v116, v116, v132
    v_add_f32 v117, v117, v133
    v_add_f32 v118, v118, v134
    v_add_f32 v104, v104, v112
    v_add_f32 v105, v105, v113
    v_add_f32 v106, v106, v114
    v_add_f32 v108, v108, v116
    v_add_f32 v109, v109, v117
    v_add_f32 v110, v110, v118
    v_add_f32 v104, v104, v108
    v_add_f32 v105, v105, v109
    v_add_f32 v106, v106, v110
    v_cvt_pk_bf16_f32 v104, v104, v104
    v_lshlrev_b32 v104, 16, v104
    v_cvt_pk_bf16_f32 v105, v105, v105
    v_lshlrev_b32 v105, 16, v105
    v_cvt_pk_bf16_f32 v106, v106, v106
    v_lshlrev_b32 v106, 16, v106
    v_cmp_lt_f32 vcc, 0, v64
    s_nop 1
    v_cndmask_b32 v52, 0, 1.0, vcc
    v_mul_f32 v52, v64, v52
    v_mul_f32 v52, v52, v104
    v_cvt_pk_bf16_f32 v32, v52, 0
    v_cmp_lt_f32 vcc, 0, v65
    s_nop 1
    v_cndmask_b32 v52, 0, 1.0, vcc
    v_mul_f32 v52, v65, v52
    v_mul_f32 v52, v52, v105
    v_cvt_pk_bf16_f32 v33, v52, 0
    v_cmp_lt_f32 vcc, 0, v66
    s_nop 1
    v_cndmask_b32 v52, 0, 1.0, vcc
    v_mul_f32 v52, v66, v52
    v_mul_f32 v52, v52, v106
    v_cvt_pk_bf16_f32 v34, v52, 0
    v_mov_b32 v8, 0
    v_mov_b32 v9, 0
    v_mov_b32 v10, 0
    v_mov_b32 v11, 0
    v_mov_b32 v12, 0
    v_mov_b32 v13, 0
    v_mov_b32 v14, 0
    v_mov_b32 v15, 0
    v_mov_b32 v16, 0
    v_mov_b32 v17, 0
    v_mov_b32 v18, 0
    v_mov_b32 v19, 0
    v_mov_b32 v20, 0
    v_mov_b32 v21, 0
    v_mov_b32 v22, 0
    v_mov_b32 v23, 0
    v_mov_b32 v24, 0
    v_mov_b32 v25, 0
    v_mov_b32 v26, 0
    v_mov_b32 v27, 0
    v_lshlrev_b32 v36, 16, v32
    v_lshlrev_b32 v37, 16, v33
    v_lshlrev_b32 v38, 16, v34
    v_dot2c_f32_bf16 v8, v32, v144
    v_dot2c_f32_bf16 v9, v36, v144
    v_dot2c_f32_bf16 v10, v32, v145
    v_dot2c_f32_bf16 v11, v36, v145
    v_dot2c_f32_bf16 v12, v32, v146
    v_dot2c_f32_bf16 v13, v36, v146
    v_dot2c_f32_bf16 v14, v32, v147
    v_dot2c_f32_bf16 v15, v36, v147
    v_dot2c_f32_bf16 v16, v32, v148
    v_dot2c_f32_bf16 v17, v36, v148
    v_dot2c_f32_bf16 v18, v32, v149
    v_dot2c_f32_bf16 v19, v36, v149
    v_dot2c_f32_bf16 v20, v32, v150
    v_dot2c_f32_bf16 v21, v36, v150
    v_dot2c_f32_bf16 v22, v32, v151
    v_dot2c_f32_bf16 v23, v36, v151
    v_dot2c_f32_bf16 v24, v32, v152
    v_dot2c_f32_bf16 v25, v36, v152
    v_dot2c_f32_bf16 v26, v32, v153
    v_dot2c_f32_bf16 v27, v36, v153
    v_dot2c_f32_bf16 v8, v33, v156
    v_dot2c_f32_bf16 v9, v37, v156
    v_dot2c_f32_bf16 v10, v33, v157
    v_dot2c_f32_bf16 v11, v37, v157
    v_dot2c_f32_bf16 v12, v33, v158
    v_dot2c_f32_bf16 v13, v37, v158
    v_dot2c_f32_bf16 v14, v33, v159
    v_dot2c_f32_bf16 v15, v37, v159
    v_dot2c_f32_bf16 v16, v33, v160
    v_dot2c_f32_bf16 v17, v37, v160
    v_dot2c_f32_bf16 v18, v33, v161
    v_dot2c_f32_bf16 v19, v37, v161
    v_dot2c_f32_bf16 v20, v33, v162
    v_dot2c_f32_bf16 v21, v37, v162
    v_dot2c_f32_bf16 v22, v33, v163
    v_dot2c_f32_bf16 v23, v37, v163
    v_dot2c_f32_bf16 v24, v33, v164
    v_dot2c_f32_bf16 v25, v37, v164
    v_dot2c_f32_bf16 v26, v33, v165
    v_dot2c_f32_bf16 v27, v37, v165
    v_dot2c_f32_bf16 v8, v34, v168
    v_dot2c_f32_bf16 v9, v38, v168
    v_dot2c_f32_bf16 v10, v34, v169
    v_dot2c_f32_bf16 v11, v38, v169
    v_dot2c_f32_bf16 v12, v34, v170
    v_dot2c_f32_bf16 v13, v38, v170
    v_dot2c_f32_bf16 v14, v34, v171
    v_dot2c_f32_bf16 v15, v38, v171
    v_dot2c_f32_bf16 v16, v34, v172
    v_dot2c_f32_bf16 v17, v38, v172
    v_dot2c_f32_bf16 v18, v34, v173
    v_dot2c_f32_bf16 v19, v38, v173
    v_dot2c_f32_bf16 v20, v34, v174
    v_dot2c_f32_bf16 v21, v38, v174
    v_dot2c_f32_bf16 v22, v34, v175
    v_dot2c_f32_bf16 v23, v38, v175
    v_dot2c_f32_bf16 v24, v34, v176
    v_dot2c_f32_bf16 v25, v38, v176
    v_dot2c_f32_bf16 v26, v34, v177
    v_dot2c_f32_bf16 v27, v38, v177
    v_add_f32_dpp v8, v8, v8 row_ror:8 row_mask:0xf bank_mask:0x3
    v_add_f32_dpp v9, v9, v9 row_ror:8 row_mask:0xf bank_mask:0x3
    v_add_f32_dpp v10, v10, v10 row_ror:8 row_mask:0xf bank_mask:0x3
    v_add_f32_dpp v11, v11, v11 row_ror:8 row_mask:0xf bank_mask:0x3
    v_add_f32_dpp v12, v12, v12 row_ror:8 row_mask:0xf bank_mask:0x3
    v_add_f32_dpp v13, v13, v13 row_ror:8 row_mask:0xf bank_mask:0x3
    v_add_f32_dpp v14, v14, v14 row_ror:8 row_mask:0xf bank_mask:0x3
    v_add_f32_dpp v15, v15, v15 row_ror:8 row_mask:0xf bank_mask:0x3
    v_add_f32_dpp v16, v16, v16 row_ror:8 row_mask:0xf bank_mask:0x3
    v_add_f32_dpp v17, v17, v17 row_ror:8 row_mask:0xf bank_mask:0x3
    v_add_f32_dpp v8, v18, v18 row_ror:8 row_mask:0xf bank_mask:0xc
    v_add_f32_dpp v9, v19, v19 row_ror:8 row_mask:0xf bank_mask:0xc
    v_add_f32_dpp v10, v20, v20 row_ror:8 row_mask:0xf bank_mask:0xc
    v_add_f32_dpp v11, v21, v21 row_ror:8 row_mask:0xf bank_mask:0xc
    v_add_f32_dpp v12, v22, v22 row_ror:8 row_mask:0xf bank_mask:0xc
    v_add_f32_dpp v13, v23, v23 row_ror:8 row_mask:0xf bank_mask:0xc
    v_add_f32_dpp v14, v24, v24 row_ror:8 row_mask:0xf bank_mask:0xc
    v_add_f32_dpp v15, v25, v25 row_ror:8 row_mask:0xf bank_mask:0xc
    v_add_f32_dpp v16, v26, v26 row_ror:8 row_mask:0xf bank_mask:0xc
    v_add_f32_dpp v17, v27, v27 row_ror:8 row_mask:0xf bank_mask:0xc
    s_nop 1
    v_permlane16_swap_b32 v8, v13
    v_permlane16_swap_b32 v9, v14
    v_permlane16_swap_b32 v10, v15
    v_permlane16_swap_b32 v11, v16
    v_permlane16_swap_b32 v12, v17
    s_nop 1
    v_add_f32 v8, v8, v13
    v_add_f32 v9, v9, v14
    v_add_f32 v10, v10, v15
    v_add_f32 v11, v11, v16
    v_add_f32 v12, v12, v17
    s_nop 1
    v_permlane32_swap_b32 v8, v11
    v_permlane32_swap_b32 v9, v12
    v_permlane32_swap_b32 v10, v13
    s_nop 1
    v_add_f32 v8, v8, v11
    v_add_f32 v9, v9, v12
    v_add_f32 v10, v10, v13
    v_mov_b32 v11, s7
    v_add_f32_dpp v8, v8, v8 quad_perm:[1,0,3,2] row_mask:0xf bank_mask:0xf
    v_add_f32_dpp v9, v9, v9 quad_perm:[1,0,3,2] row_mask:0xf bank_mask:0xf
    v_add_f32_dpp v10, v10, v10 quad_perm:[1,0,3,2] row_mask:0xf bank_mask:0xf
    v_add_f32_dpp v8, v8, v8 quad_perm:[2,3,0,1] row_mask:0xf bank_mask:0xf
    v_add_f32_dpp v9, v9, v9 quad_perm:[2,3,0,1] row_mask:0xf bank_mask:0xf
    v_add_f32_dpp v10, v10, v10 quad_perm:[2,3,0,1] row_mask:0xf bank_mask:0xf
    v_add_f32_dpp v8, v8, v8 row_half_mirror row_mask:0xf bank_mask:0xf
    v_add_f32_dpp v9, v9, v9 row_half_mirror row_mask:0xf bank_mask:0xf
    v_add_f32_dpp v10, v10, v10 row_half_mirror row_mask:0xf bank_mask:0xf
    s_mov_b32 exec_lo, 0x01010101
    s_mov_b32 exec_hi, 0x01010101
    buffer_store_dwordx4 v[8:11], v5, s[56:59], s82 offen offset:128 sc1
    s_branch L_fin
L_helper:
    s_setprio 3
    v_mov_b32 v2, 0
    ds_write_b32 v2, v2 offset:384
    v_lshrrev_b32 v3, 3, v0
    v_and_b32 v4, 7, v0
    v_mul_u32_u24 v2, 20, v0
    v_mul_u32_u24 v6, 20, v3
    v_mul_u32_u24 v5, 122880, v3
    v_lshl_add_u32 v5, v4, 4, v5
    s_mul_i32 s13, s9, 983040
    s_mul_i32 s14, s8, 384
    s_add_u32 s13, s13, s14
    s_mul_i32 s14, s9, 160
    s_waitcnt lgkmcnt(0)
    s_mov_b32 s40, s16
    s_and_b32 s41, s17, 0xffff
    s_mov_b32 s42, 1280
    s_mov_b32 s43, 0x20000
    buffer_load_dwordx4 v[44:47], v2, s[40:43], 0 offen
    buffer_load_dword v48, v2, s[40:43], 0 offen offset:16
    buffer_load_dwordx4 v[56:59], v6, s[40:43], s14 offen
    buffer_load_dword v60, v6, s[40:43], s14 offen offset:16
    s_mov_b32 s48, s22
    s_and_b32 s49, s23, 0xffff
    s_mov_b32 s50, 7864320
    s_mov_b32 s51, 0x20000
    buffer_load_dwordx4 v[64:67], v5, s[48:51], s13 offen offset:0 nt
    buffer_load_dwordx4 v[68:71], v5, s[48:51], s13 offen offset:128 nt
    buffer_load_dwordx4 v[72:75], v5, s[48:51], s13 offen offset:256 nt
    s_add_u32 s13, s13, 12288
    buffer_load_dwordx4 v[76:79], v5, s[48:51], s13 offen offset:0 nt
    buffer_load_dwordx4 v[80:83], v5, s[48:51], s13 offen offset:128 nt
    buffer_load_dwordx4 v[84:87], v5, s[48:51], s13 offen offset:256 nt
    s_add_u32 s13, s13, 12288
    buffer_load_dwordx4 v[88:91], v5, s[48:51], s13 offen offset:0 nt
    buffer_load_dwordx4 v[92:95], v5, s[48:51], s13 offen offset:128 nt
    buffer_load_dwordx4 v[96:99], v5, s[48:51], s13 offen offset:256 nt
    s_add_u32 s13, s13, 12288
    buffer_load_dwordx4 v[100:103], v5, s[48:51], s13 offen offset:0 nt
    buffer_load_dwordx4 v[104:107], v5, s[48:51], s13 offen offset:128 nt
    buffer_load_dwordx4 v[108:111], v5, s[48:51], s13 offen offset:256 nt
    s_add_u32 s13, s13, 12288
    buffer_load_dwordx4 v[112:115], v5, s[48:51], s13 offen offset:0 nt
    buffer_load_dwordx4 v[116:119], v5, s[48:51], s13 offen offset:128 nt
    buffer_load_dwordx4 v[120:123], v5, s[48:51], s13 offen offset:256 nt
    s_add_u32 s13, s13, 12288
    buffer_load_dwordx4 v[124:127], v5, s[48:51], s13 offen offset:0 nt
    buffer_load_dwordx4 v[128:131], v5, s[48:51], s13 offen offset:128 nt
    buffer_load_dwordx4 v[132:135], v5, s[48:51], s13 offen offset:256 nt
    s_add_u32 s13, s13, 12288
    buffer_load_dwordx4 v[136:139], v5, s[48:51], s13 offen offset:0 nt
    buffer_load_dwordx4 v[140:143], v5, s[48:51], s13 offen offset:128 nt
    buffer_load_dwordx4 v[144:147], v5, s[48:51], s13 offen offset:256 nt
    s_add_u32 s13, s13, 12288
    buffer_load_dwordx4 v[148:151], v5, s[48:51], s13 offen offset:0 nt
    buffer_load_dwordx4 v[152:155], v5, s[48:51], s13 offen offset:128 nt
    buffer_load_dwordx4 v[156:159], v5, s[48:51], s13 offen offset:256 nt
    s_add_u32 s13, s13, 12288
    buffer_load_dwordx4 v[160:163], v5, s[48:51], s13 offen offset:0 nt
    buffer_load_dwordx4 v[164:167], v5, s[48:51], s13 offen offset:128 nt
    buffer_load_dwordx4 v[168:171], v5, s[48:51], s13 offen offset:256 nt
    s_add_u32 s13, s13, 12288
    buffer_load_dwordx4 v[172:175], v5, s[48:51], s13 offen offset:0 nt
    buffer_load_dwordx4 v[176:179], v5, s[48:51], s13 offen offset:128 nt
    buffer_load_dwordx4 v[180:183], v5, s[48:51], s13 offen offset:256 nt
    s_barrier
    s_add_u32 s4, s38, 3145728
    s_addc_u32 s5, s39, 0
    s_load_dword s7, s[4:5], 0
    s_mov_b32 s56, s38
    s_and_b32 s57, s39, 0xffff
    s_mov_b32 s58, 4194304
    s_mov_b32 s59, 0x20000
    s_mov_b32 s76, s34
    s_and_b32 s77, s35, 0xffff
    s_mov_b32 s78, 1280
    s_mov_b32 s79, 0x20000
    v_lshrrev_b32 v2, 5, v0
    v_bfe_u32 v7, v0, 4, 1
    v_lshl_add_u32 v2, v7, 1, v2
    v_bfe_u32 v7, v0, 3, 1
    v_lshl_add_u32 v2, v7, 2, v2
    v_mul_u32_u24 v2, 3, v2
    v_add_u32 v6, 0, v2
    v_lshrrev_b32 v61, 3, v6
    v_and_b32 v6, 7, v6
    v_lshl_add_u32 v6, v61, 6, v6
    v_lshl_add_u32 v6, v4, 3, v6
    v_lshlrev_b32 v61, 1, v6
    v_add_u32 v6, 1, v2
    v_lshrrev_b32 v62, 3, v6
    v_and_b32 v6, 7, v6
    v_lshl_add_u32 v6, v62, 6, v6
    v_lshl_add_u32 v6, v4, 3, v6
    v_lshlrev_b32 v62, 1, v6
    v_add_u32 v6, 2, v2
    v_lshrrev_b32 v63, 3, v6
    v_and_b32 v6, 7, v6
    v_lshl_add_u32 v6, v63, 6, v6
    v_lshl_add_u32 v6, v4, 3, v6
    v_lshlrev_b32 v63, 1, v6
    v_lshlrev_b32 v6, 4, v0
    s_lshl_b32 s81, s8, 15
    v_mov_b32 v8, 0
    v_mov_b32 v9, 0
    v_mov_b32 v10, 0
    v_mov_b32 v11, 0
    v_mov_b32 v12, 0
    v_mov_b32 v13, 0
    v_mov_b32 v14, 0
    v_mov_b32 v15, 0
    v_mov_b32 v16, 0
    v_mov_b32 v17, 0
    v_mov_b32 v18, 0
    v_mov_b32 v19, 0
    v_mov_b32 v20, 0
    v_mov_b32 v21, 0
    v_mov_b32 v22, 0
    v_mov_b32 v23, 0
    v_mov_b32 v24, 0
    v_mov_b32 v25, 0
    v_mov_b32 v26, 0
    v_mov_b32 v27, 0
    v_mov_b32 v28, 0
    v_mov_b32 v29, 0
    v_mov_b32 v30, 0
    v_mov_b32 v31, 0
    s_waitcnt vmcnt(30)
    v_lshlrev_b32 v32, 16, v44
    v_and_b32 v33, 0xffff0000, v44
    v_lshlrev_b32 v34, 16, v45
    v_and_b32 v35, 0xffff0000, v45
    v_lshlrev_b32 v36, 16, v46
    v_and_b32 v37, 0xffff0000, v46
    v_lshlrev_b32 v38, 16, v47
    v_and_b32 v39, 0xffff0000, v47
    v_lshlrev_b32 v40, 16, v48
    v_and_b32 v41, 0xffff0000, v48
    v_add_f32 v52, v32, v33
    v_add_f32 v52, v52, v34
    v_add_f32 v52, v52, v35
    v_add_f32 v52, v52, v36
    v_add_f32 v52, v52, v37
    v_add_f32 v52, v52, v38
    v_add_f32 v52, v52, v39
    v_add_f32 v52, v52, v40
    v_add_f32 v52, v52, v41
    s_nop 1
    v_add_f32_dpp v52, v52, v52 quad_perm:[1,0,3,2] row_mask:0xf bank_mask:0xf
    s_nop 1
    v_add_f32_dpp v52, v52, v52 quad_perm:[2,3,0,1] row_mask:0xf bank_mask:0xf
    s_nop 1
    v_add_f32_dpp v52, v52, v52 row_half_mirror row_mask:0xf bank_mask:0xf
    s_nop 1
    v_add_f32_dpp v52, v52, v52 row_mirror row_mask:0xf bank_mask:0xf
    v_mov_b32 v54, v52
    s_nop 1
    v_permlane16_swap_b32 v52, v54
    s_nop 1
    v_add_f32 v52, v52, v54
    v_mov_b32 v54, v52
    s_nop 1
    v_permlane32_swap_b32 v52, v54
    s_nop 1
    v_add_f32 v52, v52, v54
    v_mul_f32 v52, 0x3acccccd, v52
    v_sub_f32 v54, v32, v52
    v_mul_f32 v53, v54, v54
    v_sub_f32 v54, v33, v52
    v_fmac_f32 v53, v54, v54
    v_sub_f32 v54, v34, v52
    v_fmac_f32 v53, v54, v54
    v_sub_f32 v54, v35, v52
    v_fmac_f32 v53, v54, v54
    v_sub_f32 v54, v36, v52
    v_fmac_f32 v53, v54, v54
    v_sub_f32 v54, v37, v52
    v_fmac_f32 v53, v54, v54
    v_sub_f32 v54, v38, v52
    v_fmac_f32 v53, v54, v54
    v_sub_f32 v54, v39, v52
    v_fmac_f32 v53, v54, v54
    v_sub_f32 v54, v40, v52
    v_fmac_f32 v53, v54, v54
    v_sub_f32 v54, v41, v52
    v_fmac_f32 v53, v54, v54
    s_nop 1
    v_add_f32_dpp v53, v53, v53 quad_perm:[1,0,3,2] row_mask:0xf bank_mask:0xf
    s_nop 1
    v_add_f32_dpp v53, v53, v53 quad_perm:[2,3,0,1] row_mask:0xf bank_mask:0xf
    s_nop 1
    v_add_f32_dpp v53, v53, v53 row_half_mirror row_mask:0xf bank_mask:0xf
    s_nop 1
    v_add_f32_dpp v53, v53, v53 row_mirror row_mask:0xf bank_mask:0xf
    v_mov_b32 v54, v53
    s_nop 1
    v_permlane16_swap_b32 v53, v54
    s_nop 1
    v_add_f32 v53, v53, v54
    v_mov_b32 v54, v53
    s_nop 1
    v_permlane32_swap_b32 v53, v54
    s_nop 1
    v_add_f32 v53, v53, v54
    v_mul_f32 v53, 0x3acccccd, v53
    v_cvt_pk_bf16_f32 v52, v52, v52
    v_lshlrev_b32 v52, 16, v52
    v_cvt_pk_bf16_f32 v53, v53, v53
    v_lshlrev_b32 v53, 16, v53
    v_add_f32 v53, 0x3727c5ac, v53
    v_cvt_pk_bf16_f32 v53, v53, v53
    v_lshlrev_b32 v53, 16, v53
    v_sqrt_f32 v53, v53
    s_nop 0
    v_cvt_pk_bf16_f32 v53, v53, v53
    v_lshlrev_b32 v53, 16, v53
    v_rcp_f32 v54, v53
    v_lshlrev_b32 v32, 16, v56
    v_and_b32 v33, 0xffff0000, v56
    v_lshlrev_b32 v34, 16, v57
    v_and_b32 v35, 0xffff0000, v57
    v_lshlrev_b32 v36, 16, v58
    v_and_b32 v37, 0xffff0000, v58
    v_lshlrev_b32 v38, 16, v59
    v_and_b32 v39, 0xffff0000, v59
    v_lshlrev_b32 v40, 16, v60
    v_and_b32 v41, 0xffff0000, v60
    v_sub_f32 v32, v32, v52
    v_cvt_pk_bf16_f32 v32, v32, v32
    v_lshlrev_b32 v32, 16, v32
    v_mul_f32 v55, v32, v54
    v_fma_f32 v32, -v55, v53, v32
    v_fmac_f32 v55, v32, v54
    v_cvt_pk_bf16_f32 v32, v55, 0
    v_sub_f32 v33, v33, v52
    v_cvt_pk_bf16_f32 v33, v33, v33
    v_lshlrev_b32 v33, 16, v33
    v_mul_f32 v55, v33, v54
    v_fma_f32 v33, -v55, v53, v33
    v_fmac_f32 v55, v33, v54
    v_cvt_pk_bf16_f32 v33, v55, 0
    v_sub_f32 v34, v34, v52
    v_cvt_pk_bf16_f32 v34, v34, v34
    v_lshlrev_b32 v34, 16, v34
    v_mul_f32 v55, v34, v54
    v_fma_f32 v34, -v55, v53, v34
    v_fmac_f32 v55, v34, v54
    v_cvt_pk_bf16_f32 v34, v55, 0
    v_sub_f32 v35, v35, v52
    v_cvt_pk_bf16_f32 v35, v35, v35
    v_lshlrev_b32 v35, 16, v35
    v_mul_f32 v55, v35, v54
    v_fma_f32 v35, -v55, v53, v35
    v_fmac_f32 v55, v35, v54
    v_cvt_pk_bf16_f32 v35, v55, 0
    v_sub_f32 v36, v36, v52
    v_cvt_pk_bf16_f32 v36, v36, v36
    v_lshlrev_b32 v36, 16, v36
    v_mul_f32 v55, v36, v54
    v_fma_f32 v36, -v55, v53, v36
    v_fmac_f32 v55, v36, v54
    v_cvt_pk_bf16_f32 v36, v55, 0
    v_sub_f32 v37, v37, v52
    v_cvt_pk_bf16_f32 v37, v37, v37
    v_lshlrev_b32 v37, 16, v37
    v_mul_f32 v55, v37, v54
    v_fma_f32 v37, -v55, v53, v37
    v_fmac_f32 v55, v37, v54
    v_cvt_pk_bf16_f32 v37, v55, 0
    v_sub_f32 v38, v38, v52
    v_cvt_pk_bf16_f32 v38, v38, v38
    v_lshlrev_b32 v38, 16, v38
    v_mul_f32 v55, v38, v54
    v_fma_f32 v38, -v55, v53, v38
    v_fmac_f32 v55, v38, v54
    v_cvt_pk_bf16_f32 v38, v55, 0
    v_sub_f32 v39, v39, v52
    v_cvt_pk_bf16_f32 v39, v39, v39
    v_lshlrev_b32 v39, 16, v39
    v_mul_f32 v55, v39, v54
    v_fma_f32 v39, -v55, v53, v39
    v_fmac_f32 v55, v39, v54
    v_cvt_pk_bf16_f32 v39, v55, 0
    v_sub_f32 v40, v40, v52
    v_cvt_pk_bf16_f32 v40, v40, v40
    v_lshlrev_b32 v40, 16, v40
    v_mul_f32 v55, v40, v54
    v_fma_f32 v40, -v55, v53, v40
    v_fmac_f32 v55, v40, v54
    v_cvt_pk_bf16_f32 v40, v55, 0
    v_sub_f32 v41, v41, v52
    v_cvt_pk_bf16_f32 v41, v41, v41
    v_lshlrev_b32 v41, 16, v41
    v_mul_f32 v55, v41, v54
    v_fma_f32 v41, -v55, v53, v41
    v_fmac_f32 v55, v41, v54
    v_cvt_pk_bf16_f32 v41, v55, 0
    v_lshlrev_b32 v52, 16, v32
    s_waitcnt vmcnt(27)
    v_dot2c_f32_bf16 v8, v32, v64
    v_dot2c_f32_bf16 v9, v52, v64
    v_dot2c_f32_bf16 v10, v32, v65
    v_dot2c_f32_bf16 v11, v52, v65
    v_dot2c_f32_bf16 v12, v32, v66
    v_dot2c_f32_bf16 v13, v52, v66
    v_dot2c_f32_bf16 v14, v32, v67
    v_dot2c_f32_bf16 v15, v52, v67
    v_dot2c_f32_bf16 v16, v32, v68
    v_dot2c_f32_bf16 v17, v52, v68
    v_dot2c_f32_bf16 v18, v32, v69
    v_dot2c_f32_bf16 v19, v52, v69
    v_dot2c_f32_bf16 v20, v32, v70
    v_dot2c_f32_bf16 v21, v52, v70
    v_dot2c_f32_bf16 v22, v32, v71
    v_dot2c_f32_bf16 v23, v52, v71
    v_dot2c_f32_bf16 v24, v32, v72
    v_dot2c_f32_bf16 v25, v52, v72
    v_dot2c_f32_bf16 v26, v32, v73
    v_dot2c_f32_bf16 v27, v52, v73
    v_dot2c_f32_bf16 v28, v32, v74
    v_dot2c_f32_bf16 v29, v52, v74
    v_dot2c_f32_bf16 v30, v32, v75
    v_dot2c_f32_bf16 v31, v52, v75
    v_lshlrev_b32 v52, 16, v33
    s_waitcnt vmcnt(24)
    v_dot2c_f32_bf16 v8, v33, v76
    v_dot2c_f32_bf16 v9, v52, v76
    v_dot2c_f32_bf16 v10, v33, v77
    v_dot2c_f32_bf16 v11, v52, v77
    v_dot2c_f32_bf16 v12, v33, v78
    v_dot2c_f32_bf16 v13, v52, v78
    v_dot2c_f32_bf16 v14, v33, v79
    v_dot2c_f32_bf16 v15, v52, v79
    v_dot2c_f32_bf16 v16, v33, v80
    v_dot2c_f32_bf16 v17, v52, v80
    v_dot2c_f32_bf16 v18, v33, v81
    v_dot2c_f32_bf16 v19, v52, v81
    v_dot2c_f32_bf16 v20, v33, v82
    v_dot2c_f32_bf16 v21, v52, v82
    v_dot2c_f32_bf16 v22, v33, v83
    v_dot2c_f32_bf16 v23, v52, v83
    v_dot2c_f32_bf16 v24, v33, v84
    v_dot2c_f32_bf16 v25, v52, v84
    v_dot2c_f32_bf16 v26, v33, v85
    v_dot2c_f32_bf16 v27, v52, v85
    v_dot2c_f32_bf16 v28, v33, v86
    v_dot2c_f32_bf16 v29, v52, v86
    v_dot2c_f32_bf16 v30, v33, v87
    v_dot2c_f32_bf16 v31, v52, v87
    v_lshlrev_b32 v52, 16, v34
    s_waitcnt vmcnt(21)
    v_dot2c_f32_bf16 v8, v34, v88
    v_dot2c_f32_bf16 v9, v52, v88
    v_dot2c_f32_bf16 v10, v34, v89
    v_dot2c_f32_bf16 v11, v52, v89
    v_dot2c_f32_bf16 v12, v34, v90
    v_dot2c_f32_bf16 v13, v52, v90
    v_dot2c_f32_bf16 v14, v34, v91
    v_dot2c_f32_bf16 v15, v52, v91
    v_dot2c_f32_bf16 v16, v34, v92
    v_dot2c_f32_bf16 v17, v52, v92
    v_dot2c_f32_bf16 v18, v34, v93
    v_dot2c_f32_bf16 v19, v52, v93
    v_dot2c_f32_bf16 v20, v34, v94
    v_dot2c_f32_bf16 v21, v52, v94
    v_dot2c_f32_bf16 v22, v34, v95
    v_dot2c_f32_bf16 v23, v52, v95
    v_dot2c_f32_bf16 v24, v34, v96
    v_dot2c_f32_bf16 v25, v52, v96
    v_dot2c_f32_bf16 v26, v34, v97
    v_dot2c_f32_bf16 v27, v52, v97
    v_dot2c_f32_bf16 v28, v34, v98
    v_dot2c_f32_bf16 v29, v52, v98
    v_dot2c_f32_bf16 v30, v34, v99
    v_dot2c_f32_bf16 v31, v52, v99
    v_lshlrev_b32 v52, 16, v35
    s_waitcnt vmcnt(18)
    v_dot2c_f32_bf16 v8, v35, v100
    v_dot2c_f32_bf16 v9, v52, v100
    v_dot2c_f32_bf16 v10, v35, v101
    v_dot2c_f32_bf16 v11, v52, v101
    v_dot2c_f32_bf16 v12, v35, v102
    v_dot2c_f32_bf16 v13, v52, v102
    v_dot2c_f32_bf16 v14, v35, v103
    v_dot2c_f32_bf16 v15, v52, v103
    v_dot2c_f32_bf16 v16, v35, v104
    v_dot2c_f32_bf16 v17, v52, v104
    v_dot2c_f32_bf16 v18, v35, v105
    v_dot2c_f32_bf16 v19, v52, v105
    v_dot2c_f32_bf16 v20, v35, v106
    v_dot2c_f32_bf16 v21, v52, v106
    v_dot2c_f32_bf16 v22, v35, v107
    v_dot2c_f32_bf16 v23, v52, v107
    v_dot2c_f32_bf16 v24, v35, v108
    v_dot2c_f32_bf16 v25, v52, v108
    v_dot2c_f32_bf16 v26, v35, v109
    v_dot2c_f32_bf16 v27, v52, v109
    v_dot2c_f32_bf16 v28, v35, v110
    v_dot2c_f32_bf16 v29, v52, v110
    v_dot2c_f32_bf16 v30, v35, v111
    v_dot2c_f32_bf16 v31, v52, v111
    v_lshlrev_b32 v52, 16, v36
    s_waitcnt vmcnt(15)
    v_dot2c_f32_bf16 v8, v36, v112
    v_dot2c_f32_bf16 v9, v52, v112
    v_dot2c_f32_bf16 v10, v36, v113
    v_dot2c_f32_bf16 v11, v52, v113
    v_dot2c_f32_bf16 v12, v36, v114
    v_dot2c_f32_bf16 v13, v52, v114
    v_dot2c_f32_bf16 v14, v36, v115
    v_dot2c_f32_bf16 v15, v52, v115
    v_dot2c_f32_bf16 v16, v36, v116
    v_dot2c_f32_bf16 v17, v52, v116
    v_dot2c_f32_bf16 v18, v36, v117
    v_dot2c_f32_bf16 v19, v52, v117
    v_dot2c_f32_bf16 v20, v36, v118
    v_dot2c_f32_bf16 v21, v52, v118
    v_dot2c_f32_bf16 v22, v36, v119
    v_dot2c_f32_bf16 v23, v52, v119
    v_dot2c_f32_bf16 v24, v36, v120
    v_dot2c_f32_bf16 v25, v52, v120
    v_dot2c_f32_bf16 v26, v36, v121
    v_dot2c_f32_bf16 v27, v52, v121
    v_dot2c_f32_bf16 v28, v36, v122
    v_dot2c_f32_bf16 v29, v52, v122
    v_dot2c_f32_bf16 v30, v36, v123
    v_dot2c_f32_bf16 v31, v52, v123
    v_lshlrev_b32 v52, 16, v37
    s_waitcnt vmcnt(12)
    v_dot2c_f32_bf16 v8, v37, v124
    v_dot2c_f32_bf16 v9, v52, v124
    v_dot2c_f32_bf16 v10, v37, v125
    v_dot2c_f32_bf16 v11, v52, v125
    v_dot2c_f32_bf16 v12, v37, v126
    v_dot2c_f32_bf16 v13, v52, v126
    v_dot2c_f32_bf16 v14, v37, v127
    v_dot2c_f32_bf16 v15, v52, v127
    v_dot2c_f32_bf16 v16, v37, v128
    v_dot2c_f32_bf16 v17, v52, v128
    v_dot2c_f32_bf16 v18, v37, v129
    v_dot2c_f32_bf16 v19, v52, v129
    v_dot2c_f32_bf16 v20, v37, v130
    v_dot2c_f32_bf16 v21, v52, v130
    v_dot2c_f32_bf16 v22, v37, v131
    v_dot2c_f32_bf16 v23, v52, v131
    v_dot2c_f32_bf16 v24, v37, v132
    v_dot2c_f32_bf16 v25, v52, v132
    v_dot2c_f32_bf16 v26, v37, v133
    v_dot2c_f32_bf16 v27, v52, v133
    v_dot2c_f32_bf16 v28, v37, v134
    v_dot2c_f32_bf16 v29, v52, v134
    v_dot2c_f32_bf16 v30, v37, v135
    v_dot2c_f32_bf16 v31, v52, v135
    v_lshlrev_b32 v52, 16, v38
    s_waitcnt vmcnt(9)
    v_dot2c_f32_bf16 v8, v38, v136
    v_dot2c_f32_bf16 v9, v52, v136
    v_dot2c_f32_bf16 v10, v38, v137
    v_dot2c_f32_bf16 v11, v52, v137
    v_dot2c_f32_bf16 v12, v38, v138
    v_dot2c_f32_bf16 v13, v52, v138
    v_dot2c_f32_bf16 v14, v38, v139
    v_dot2c_f32_bf16 v15, v52, v139
    v_dot2c_f32_bf16 v16, v38, v140
    v_dot2c_f32_bf16 v17, v52, v140
    v_dot2c_f32_bf16 v18, v38, v141
    v_dot2c_f32_bf16 v19, v52, v141
    v_dot2c_f32_bf16 v20, v38, v142
    v_dot2c_f32_bf16 v21, v52, v142
    v_dot2c_f32_bf16 v22, v38, v143
    v_dot2c_f32_bf16 v23, v52, v143
    v_dot2c_f32_bf16 v24, v38, v144
    v_dot2c_f32_bf16 v25, v52, v144
    v_dot2c_f32_bf16 v26, v38, v145
    v_dot2c_f32_bf16 v27, v52, v145
    v_dot2c_f32_bf16 v28, v38, v146
    v_dot2c_f32_bf16 v29, v52, v146
    v_dot2c_f32_bf16 v30, v38, v147
    v_dot2c_f32_bf16 v31, v52, v147
    v_lshlrev_b32 v52, 16, v39
    s_waitcnt vmcnt(6)
    v_dot2c_f32_bf16 v8, v39, v148
    v_dot2c_f32_bf16 v9, v52, v148
    v_dot2c_f32_bf16 v10, v39, v149
    v_dot2c_f32_bf16 v11, v52, v149
    v_dot2c_f32_bf16 v12, v39, v150
    v_dot2c_f32_bf16 v13, v52, v150
    v_dot2c_f32_bf16 v14, v39, v151
    v_dot2c_f32_bf16 v15, v52, v151
    v_dot2c_f32_bf16 v16, v39, v152
    v_dot2c_f32_bf16 v17, v52, v152
    v_dot2c_f32_bf16 v18, v39, v153
    v_dot2c_f32_bf16 v19, v52, v153
    v_dot2c_f32_bf16 v20, v39, v154
    v_dot2c_f32_bf16 v21, v52, v154
    v_dot2c_f32_bf16 v22, v39, v155
    v_dot2c_f32_bf16 v23, v52, v155
    v_dot2c_f32_bf16 v24, v39, v156
    v_dot2c_f32_bf16 v25, v52, v156
    v_dot2c_f32_bf16 v26, v39, v157
    v_dot2c_f32_bf16 v27, v52, v157
    v_dot2c_f32_bf16 v28, v39, v158
    v_dot2c_f32_bf16 v29, v52, v158
    v_dot2c_f32_bf16 v30, v39, v159
    v_dot2c_f32_bf16 v31, v52, v159
    v_lshlrev_b32 v52, 16, v40
    s_waitcnt vmcnt(3)
    v_dot2c_f32_bf16 v8, v40, v160
    v_dot2c_f32_bf16 v9, v52, v160
    v_dot2c_f32_bf16 v10, v40, v161
    v_dot2c_f32_bf16 v11, v52, v161
    v_dot2c_f32_bf16 v12, v40, v162
    v_dot2c_f32_bf16 v13, v52, v162
    v_dot2c_f32_bf16 v14, v40, v163
    v_dot2c_f32_bf16 v15, v52, v163
    v_dot2c_f32_bf16 v16, v40, v164
    v_dot2c_f32_bf16 v17, v52, v164
    v_dot2c_f32_bf16 v18, v40, v165
    v_dot2c_f32_bf16 v19, v52, v165
    v_dot2c_f32_bf16 v20, v40, v166
    v_dot2c_f32_bf16 v21, v52, v166
    v_dot2c_f32_bf16 v22, v40, v167
    v_dot2c_f32_bf16 v23, v52, v167
    v_dot2c_f32_bf16 v24, v40, v168
    v_dot2c_f32_bf16 v25, v52, v168
    v_dot2c_f32_bf16 v26, v40, v169
    v_dot2c_f32_bf16 v27, v52, v169
    v_dot2c_f32_bf16 v28, v40, v170
    v_dot2c_f32_bf16 v29, v52, v170
    v_dot2c_f32_bf16 v30, v40, v171
    v_dot2c_f32_bf16 v31, v52, v171
    v_lshlrev_b32 v52, 16, v41
    s_waitcnt vmcnt(0)
    v_dot2c_f32_bf16 v8, v41, v172
    v_dot2c_f32_bf16 v9, v52, v172
    v_dot2c_f32_bf16 v10, v41, v173
    v_dot2c_f32_bf16 v11, v52, v173
    v_dot2c_f32_bf16 v12, v41, v174
    v_dot2c_f32_bf16 v13, v52, v174
    v_dot2c_f32_bf16 v14, v41, v175
    v_dot2c_f32_bf16 v15, v52, v175
    v_dot2c_f32_bf16 v16, v41, v176
    v_dot2c_f32_bf16 v17, v52, v176
    v_dot2c_f32_bf16 v18, v41, v177
    v_dot2c_f32_bf16 v19, v52, v177
    v_dot2c_f32_bf16 v20, v41, v178
    v_dot2c_f32_bf16 v21, v52, v178
    v_dot2c_f32_bf16 v22, v41, v179
    v_dot2c_f32_bf16 v23, v52, v179
    v_dot2c_f32_bf16 v24, v41, v180
    v_dot2c_f32_bf16 v25, v52, v180
    v_dot2c_f32_bf16 v26, v41, v181
    v_dot2c_f32_bf16 v27, v52, v181
    v_dot2c_f32_bf16 v28, v41, v182
    v_dot2c_f32_bf16 v29, v52, v182
    v_dot2c_f32_bf16 v30, v41, v183
    v_dot2c_f32_bf16 v31, v52, v183
    s_nop 1
    v_add_f32_dpp v8, v8, v8 row_ror:8 row_mask:0xf bank_mask:0x3
    v_add_f32_dpp v9, v9, v9 row_ror:8 row_mask:0xf bank_mask:0x3
    v_add_f32_dpp v10, v10, v10 row_ror:8 row_mask:0xf bank_mask:0x3
    v_add_f32_dpp v11, v11, v11 row_ror:8 row_mask:0xf bank_mask:0x3
    v_add_f32_dpp v12, v12, v12 row_ror:8 row_mask:0xf bank_mask:0x3
    v_add_f32_dpp v13, v13, v13 row_ror:8 row_mask:0xf bank_mask:0x3
    v_add_f32_dpp v14, v14, v14 row_ror:8 row_mask:0xf bank_mask:0x3
    v_add_f32_dpp v15, v15, v15 row_ror:8 row_mask:0xf bank_mask:0x3
    v_add_f32_dpp v16, v16, v16 row_ror:8 row_mask:0xf bank_mask:0x3
    v_add_f32_dpp v17, v17, v17 row_ror:8 row_mask:0xf bank_mask:0x3
    v_add_f32_dpp v18, v18, v18 row_ror:8 row_mask:0xf bank_mask:0x3
    v_add_f32_dpp v19, v19, v19 row_ror:8 row_mask:0xf bank_mask:0x3
    v_add_f32_dpp v8, v20, v20 row_ror:8 row_mask:0xf bank_mask:0xc
    v_add_f32_dpp v9, v21, v21 row_ror:8 row_mask:0xf bank_mask:0xc
    v_add_f32_dpp v10, v22, v22 row_ror:8 row_mask:0xf bank_mask:0xc
    v_add_f32_dpp v11, v23, v23 row_ror:8 row_mask:0xf bank_mask:0xc
    v_add_f32_dpp v12, v24, v24 row_ror:8 row_mask:0xf bank_mask:0xc
    v_add_f32_dpp v13, v25, v25 row_ror:8 row_mask:0xf bank_mask:0xc
    v_add_f32_dpp v14, v26, v26 row_ror:8 row_mask:0xf bank_mask:0xc
    v_add_f32_dpp v15, v27, v27 row_ror:8 row_mask:0xf bank_mask:0xc
    v_add_f32_dpp v16, v28, v28 row_ror:8 row_mask:0xf bank_mask:0xc
    v_add_f32_dpp v17, v29, v29 row_ror:8 row_mask:0xf bank_mask:0xc
    v_add_f32_dpp v18, v30, v30 row_ror:8 row_mask:0xf bank_mask:0xc
    v_add_f32_dpp v19, v31, v31 row_ror:8 row_mask:0xf bank_mask:0xc
    s_nop 1
    v_permlane16_swap_b32 v8, v14
    v_permlane16_swap_b32 v9, v15
    v_permlane16_swap_b32 v10, v16
    v_permlane16_swap_b32 v11, v17
    v_permlane16_swap_b32 v12, v18
    v_permlane16_swap_b32 v13, v19
    s_nop 1
    v_add_f32 v8, v8, v14
    v_add_f32 v9, v9, v15
    v_add_f32 v10, v10, v16
    v_add_f32 v11, v11, v17
    v_add_f32 v12, v12, v18
    v_add_f32 v13, v13, v19
    s_nop 1
    v_permlane32_swap_b32 v8, v11
    v_permlane32_swap_b32 v9, v12
    v_permlane32_swap_b32 v10, v13
    s_nop 1
    v_add_f32 v8, v8, v11
    v_add_f32 v9, v9, v12
    v_add_f32 v10, v10, v13
    s_waitcnt lgkmcnt(0)
    s_add_u32 s7, s7, 0x9e3779b9
    s_and_b32 s7, s7, 0xfffffff0
    v_mov_b32 v11, s7
    buffer_store_dwordx4 v[8:11], v6, s[56:59], s10 offen offset:2560 sc1
    s_barrier
    s_mov_b32 s12, 262144
L_pq:
    s_add_u32 s83, s81, 0
    buffer_load_dwordx4 v[64:67], v6, s[56:59], s83 offen offset:2560 sc1
    s_add_u32 s83, s81, 4096
    buffer_load_dwordx4 v[68:71], v6, s[56:59], s83 offen offset:2560 sc1
    s_add_u32 s83, s81, 8192
    buffer_load_dwordx4 v[72:75], v6, s[56:59], s83 offen offset:2560 sc1
    s_add_u32 s83, s81, 12288
    buffer_load_dwordx4 v[76:79], v6, s[56:59], s83 offen offset:2560 sc1
    s_add_u32 s83, s81, 16384
    buffer_load_dwordx4 v[80:83], v6, s[56:59], s83 offen offset:2560 sc1
    s_add_u32 s83, s81, 20480
    buffer_load_dwordx4 v[84:87], v6, s[56:59], s83 offen offset:2560 sc1
    s_add_u32 s83, s81, 24576
    buffer_load_dwordx4 v[88:91], v6, s[56:59], s83 offen offset:2560 sc1
    s_add_u32 s83, s81, 28672
    buffer_load_dwordx4 v[92:95], v6, s[56:59], s83 offen offset:2560 sc1
    s_sub_u32 s12, s12, 1
    s_cbranch_scc1 L_pqx
    s_waitcnt vmcnt(0)
    v_min3_u32 v52, v67, v71, v75
    v_min3_u32 v52, v52, v79, v83
    v_min3_u32 v52, v52, v87, v91
    v_min_u32 v52, v52, v95
    v_max3_u32 v53, v67, v71, v75
    v_max3_u32 v53, v53, v79, v83
    v_max3_u32 v53, v53, v87, v91
    v_max_u32 v53, v53, v95
    v_cmp_ne_u32 vcc, s7, v52
    v_cmp_ne_u32 s[4:5], s7, v53
    s_nop 0
    s_or_b64 vcc, vcc, s[4:5]
    s_cbranch_scc1 L_pq
L_pqx:
    s_waitcnt vmcnt(0)
    v_add_f32 v64, v64, v80
    v_add_f32 v65, v65, v81
    v_add_f32 v66, v66, v82
    v_add_f32 v68, v68, v84
    v_add_f32 v69, v69, v85
    v_add_f32 v70, v70, v86
    v_add_f32 v72, v72, v88
    v_add_f32 v73, v73, v89
    v_add_f32 v74, v74, v90
    v_add_f32 v76, v76, v92
    v_add_f32 v77, v77, v93
    v_add_f32 v78, v78, v94
    v_add_f32 v64, v64, v72
    v_add_f32 v65, v65, v73
    v_add_f32 v66, v66, v74
    v_add_f32 v68, v68, v76
    v_add_f32 v69, v69, v77
    v_add_f32 v70, v70, v78
    v_add_f32 v64, v64, v68
    v_add_f32 v65, v65, v69
    v_add_f32 v66, v66, v70
    v_cvt_pk_bf16_f32 v64, v64, v64
    v_cvt_pk_bf16_f32 v65, v65, v65
    v_cvt_pk_bf16_f32 v66, v66, v66
    ds_write_b16 v61, v64 offset:0
    ds_write_b16 v62, v65 offset:0
    ds_write_b16 v63, v66 offset:0
    s_waitcnt lgkmcnt(0)
    v_mov_b32 v2, 0
    v_mov_b32 v7, 1
    ds_write_b32 v2, v7 offset:384
    s_waitcnt lgkmcnt(0)
    s_mov_b32 s64, s36
    s_and_b32 s65, s37, 0xffff
    s_mov_b32 s66, 256
    s_mov_b32 s67, 0x20000
    ds_write_b32 v2, v2 offset:14392
    ds_write_b32 v2, v7 offset:14388
    v_mov_b32 v20, 1
    v_mov_b32 v6, 0
    s_waitcnt lgkmcnt(0)
    s_barrier
    s_mov_b64 exec, 1
    buffer_atomic_add v20, v6, s[64:67], 0 offen sc0
    s_mov_b64 exec, -1
    v_and_b32 v2, 3, v0
    v_lshlrev_b32 v2, 3, v2
    ds_read_b64 v[8:9], v2 offset:14336
    s_waitcnt lgkmcnt(0)
    v_max_f32_dpp v12, v8, v8 quad_perm:[1,0,3,2] row_mask:0xf bank_mask:0xf
    s_nop 1
    v_max_f32_dpp v12, v12, v12 quad_perm:[2,3,0,1] row_mask:0xf bank_mask:0xf
    v_sub_f32 v54, v8, v12
    v_mul_f32 v54, 0x3fb8aa3b, v54
    v_exp_f32 v54, v54
    s_nop 0
    v_mul_f32 v13, v54, v9
    s_nop 1
    v_add_f32_dpp v13, v13, v13 quad_perm:[1,0,3,2] row_mask:0xf bank_mask:0xf
    s_nop 1
    v_add_f32_dpp v13, v13, v13 quad_perm:[2,3,0,1] row_mask:0xf bank_mask:0xf
    s_getreg_b32 s61, hwreg(HW_REG_XCC_ID)
    s_and_b32 s61, s61, 15
    v_mov_b32 v14, s61
    v_mov_b32 v15, s7
    v_lshlrev_b32 v2, 4, v0
    s_mov_b64 exec, 15
    buffer_store_dwordx4 v[12:15], v2, s[56:59], s10 offen offset:256 sc1
    s_mov_b64 exec, -1
    v_and_b32 v2, 7, v0
    v_lshlrev_b32 v2, 12, v2
    s_mov_b32 s12, 262144
L_pms:
    s_sleep 32
L_pm:
    buffer_load_dwordx4 v[16:19], v2, s[56:59], s81 offen offset:256 sc1
    s_sub_u32 s12, s12, 1
    s_cbranch_scc1 L_pmx
    s_waitcnt vmcnt(0)
    v_cmp_ne_u32 vcc, s7, v19
    s_nop 0
    s_cmp_lg_u64 vcc, 0
    s_cbranch_scc1 L_pms
L_pmx:
    s_waitcnt vmcnt(0)
    v_cmp_ne_u32 vcc, s61, v18
    v_mov_b32 v2, 0
    s_cmp_eq_u64 vcc, 0
    s_cselect_b32 s61, 1, 0
    v_mov_b32 v7, s61
    ds_write_b32 v2, v7 offset:14384
    v_readfirstlane_b32 s61, v20
    s_mov_b32 s62, 0
    s_cmp_ge_u32 s61, 48
    s_addc_u32 s62, s62, 0
    s_cmp_ge_u32 s61, 112
    s_addc_u32 s62, s62, 0
    s_cmp_ge_u32 s61, 160
    s_addc_u32 s62, s62, 0
    s_cmp_ge_u32 s61, 200
    s_addc_u32 s62, s62, 0
    s_cmp_ge_u32 s61, 232
    s_addc_u32 s62, s62, 0
    s_cmp_ge_u32 s61, 248
    s_addc_u32 s62, s62, 0
    v_mov_b32 v7, s62
    ds_write_b32 v6, v7 offset:14388
    v_max_f32_dpp v52, v16, v16 quad_perm:[1,0,3,2] row_mask:0xf bank_mask:0xf
    s_nop 1
    v_max_f32_dpp v52, v52, v52 quad_perm:[2,3,0,1] row_mask:0xf bank_mask:0xf
    s_nop 1
    v_max_f32_dpp v52, v52, v52 row_half_mirror row_mask:0xf bank_mask:0xf
    v_sub_f32 v54, v16, v52
    v_mul_f32 v54, 0x3fb8aa3b, v54
    v_exp_f32 v54, v54
    s_nop 0
    v_mul_f32 v53, v54, v17
    s_nop 1
    v_add_f32_dpp v53, v53, v53 quad_perm:[1,0,3,2] row_mask:0xf bank_mask:0xf
    s_nop 1
    v_add_f32_dpp v53, v53, v53 quad_perm:[2,3,0,1] row_mask:0xf bank_mask:0xf
    s_nop 1
    v_add_f32_dpp v53, v53, v53 row_half_mirror row_mask:0xf bank_mask:0xf
    s_nop 1
    v_rcp_f32 v53, v53
    v_sub_f32 v54, v8, v52
    v_mul_f32 v54, 0x3fb8aa3b, v54
    v_exp_f32 v54, v54
    s_nop 0
    v_mul_f32 v54, v54, v53
    v_and_b32 v2, 3, v0
    v_lshlrev_b32 v2, 2, v2
    ds_write_b32 v2, v54 offset:14368
    s_cmp_ge_u32 s8, 16
    s_cbranch_scc1 L_nofin
    s_lshl_b32 s81, s9, 2
    s_lshr_b32 s13, s8, 2
    s_add_u32 s81, s81, s13
    s_lshl_b32 s81, s81, 12
    s_and_b32 s13, s8, 3
    s_lshl_b32 s13, s13, 5
    s_add_u32 s81, s81, s13
    v_lshrrev_b32 v3, 1, v0
    v_and_b32 v7, 1, v0
    v_lshlrev_b32 v6, 4, v7
    v_lshl_add_u32 v2, v3, 17, v6
    v_mov_b32 v24, 0
    v_mov_b32 v25, 0
    v_mov_b32 v26, 0
    v_mov_b32 v27, 0
    s_mov_b64 exec, 0xffff
    s_mov_b32 s12, 262144
    s_branch L_pf
L_pfs:
    s_sleep 32
L_pf:
    buffer_load_dwordx4 v[24:27], v2, s[56:59], s81 offen offset:128 sc1
    s_sub_u32 s12, s12, 1
    s_cbranch_scc1 L_pfx
    s_waitcnt vmcnt(0)
    v_cmp_ne_u32 vcc, s7, v27
    s_nop 0
    s_cmp_lg_u64 vcc, 0
    s_cbranch_scc1 L_pfs
L_pfx:
    s_waitcnt vmcnt(0)
    s_mov_b64 exec, -1
    v_lshl_add_u32 v2, v3, 15, v6
    s_lshl_b32 s81, s9, 12
    s_lshl_b32 s13, s8, 5
    s_add_u32 s81, s81, s13
    s_nop 1
    v_permlane32_swap_b32 v24, v26
    v_permlane32_swap_b32 v25, v27
    s_nop 1
    v_add_f32 v24, v24, v26
    v_add_f32 v25, v25, v27
    s_nop 1
    v_permlane16_swap_b32 v24, v25
    s_nop 1
    v_add_f32 v24, v24, v25
    s_nop 1
    v_add_f32_dpp v24, v24, v24 row_ror:8 row_mask:0xf bank_mask:0xf
    s_nop 1
    v_add_f32_dpp v24, v24, v24 row_ror:4 row_mask:0xf bank_mask:0xf
    s_nop 1
    v_add_f32_dpp v24, v24, v24 row_ror:2 row_mask:0xf bank_mask:0xf
    v_cvt_pk_bf16_f32 v24, v24, v24
    v_lshlrev_b32 v24, 16, v24
    s_mul_i32 s13, s9, 160
    s_mul_i32 s14, s8, 10
    s_add_u32 s82, s13, s14
    v_lshrrev_b32 v5, 4, v0
    v_mul_u32_u24 v7, 3, v7
    v_add_lshl_u32 v5, v5, v7, 1
    buffer_load_ushort v25, v5, s[40:43], s82 offen
    s_waitcnt vmcnt(0)
    v_lshlrev_b32 v25, 16, v25
    s_waitcnt lgkmcnt(0)
    s_barrier
    s_barrier
    s_mov_b32 s12, 262144
L_pa:
    buffer_load_dwordx4 v[8:11], v2, s[56:59], s81 offen offset:2048 sc1
    s_sub_u32 s12, s12, 1
    s_cbranch_scc1 L_pax
    s_waitcnt vmcnt(0)
    v_cmp_ne_u32 vcc, s7, v11
    s_nop 0
    s_cmp_lg_u64 vcc, 0
    s_cbranch_scc1 L_pa
L_pax:
    s_waitcnt vmcnt(0)
    s_nop 1
    v_permlane32_swap_b32 v8, v10
    v_permlane32_swap_b32 v9, v11
    s_nop 1
    v_add_f32 v8, v8, v10
    v_add_f32 v9, v9, v11
    s_nop 1
    v_permlane16_swap_b32 v8, v9
    s_nop 1
    v_add_f32 v8, v8, v9
    s_nop 1
    v_add_f32_dpp v8, v8, v8 row_ror:8 row_mask:0xf bank_mask:0xf
    s_nop 1
    v_add_f32_dpp v8, v8, v8 row_ror:4 row_mask:0xf bank_mask:0xf
    s_nop 1
    v_add_f32_dpp v8, v8, v8 row_ror:2 row_mask:0xf bank_mask:0xf
    v_cvt_pk_bf16_f32 v8, v8, v8
    v_lshlrev_b32 v8, 16, v8
    v_add_f32 v8, v8, v25
    v_cvt_pk_bf16_f32 v8, v8, v8
    v_lshlrev_b32 v8, 16, v8
    v_add_f32 v8, v8, v24
    v_cvt_pk_bf16_f32 v8, v8, v8
    s_mov_b32 exec_lo, 0x00030003
    s_mov_b32 exec_hi, 1
    buffer_store_short v8, v5, s[76:79], s82 offen
    s_cmp_lg_u32 s10, 0
    s_cbranch_scc1 L_fin
    s_mov_b64 exec, 1
    v_mov_b32 v2, 3145728
    v_mov_b32 v7, s7
    buffer_store_dword v7, v2, s[56:59], 0 offen sc1
    s_branch L_fin
L_nofin:
    s_waitcnt lgkmcnt(0)
    s_barrier
L_fin:
L_end:
    s_endpgm
.section .rodata,"a"
.p2align 6
.amdhsa_kernel parallel_sum__gqa_block_cached__glu_gated_reglu__decode_kernel
  .amdhsa_next_free_vgpr 240
  .amdhsa_next_free_sgpr 102
  .amdhsa_accum_offset 240
  .amdhsa_group_segment_fixed_size 0
  .amdhsa_kernarg_size 96
  .amdhsa_user_sgpr_count 2
  .amdhsa_user_sgpr_kernarg_segment_ptr 1
  .amdhsa_system_sgpr_workgroup_id_x 1
.end_amdhsa_kernel
```
